```python
import torch

def _softmax(x, axis=-1):
    return torch.softmax(x, dim=axis)
def _gelu(x):
    return torch.nn.functional.gelu(x, approximate="tanh")
def _silu(x):
    return torch.nn.functional.silu(x)
def _sigmoid(x):
    return torch.sigmoid(x)
def _layernorm(x, axis=-1, eps=1e-5):
    m = x.mean(dim=axis, keepdim=True)
    v = x.var(dim=axis, keepdim=True, unbiased=False)
    return (x - m) / torch.sqrt(v + eps)
def _scatter_add(tgt, idx, src, axis=0):
    return tgt.clone().index_add_(axis, idx, src)
def _segment_sum(src, seg, n):
    out = torch.zeros((n,) + src.shape[1:], dtype=src.dtype)
    return out.index_add_(0, seg, src)
def _pad(x, pw):
    flat = tuple(v for pair in reversed(pw) for v in pair)
    return torch.nn.functional.pad(x, flat)

kernel_name = 'gated_mix__gqa_block_cached__glu_gated_glu__decode'

def setup_inputs():

    _w = (lambda a: (lambda t: t.to(torch.bfloat16) if t.is_floating_point() else t)(torch.as_tensor(a)))
    def _A_setup():
        B, Sq, D = 4, 1, 512
        Hq, Hkv, Sk, Dh = 32, 8, 8192, 128
        assert Hq % Hkv == 0, (Hq, Hkv)
        return {
            "x": _w((lambda *s: torch.randn(*s, dtype=torch.bfloat16) * 0.05)(B, Sq, D)),
            "k_cache": _w((lambda *s: torch.randn(*s, dtype=torch.bfloat16) * 6.4)(B, Hkv, Sk, Dh)),
            "v_cache": _w((lambda *s: torch.randn(*s, dtype=torch.bfloat16) * 3.2)(B, Hkv, Sk, Dh)),
            "wq": _w((lambda *s: torch.randn(*s, dtype=torch.bfloat16) * 6.4)(D, Hq * Dh) * (D ** -0.5)),
            "wo": _w((lambda *s: torch.randn(*s, dtype=torch.bfloat16) * 3.2)(Hq * Dh, D) * ((Hq * Dh) ** -0.5)),
        }
    _A_in = _A_setup()

    def _B_setup():
        B, S, D, F = 4, 1, 512, 1792
        return {
            "x": _w((lambda *s: torch.randn(*s, dtype=torch.bfloat16) * 0.05)(B, S, D)),
            "w_gate": _w((lambda *s: torch.randn(*s, dtype=torch.bfloat16) * 3.2)(D, F)),
            "w_up": _w((lambda *s: torch.randn(*s, dtype=torch.bfloat16) * 0.2)(D, F)),
            "w_down": _w((lambda *s: torch.randn(*s, dtype=torch.bfloat16) * 0.2)(F, D)),
        }
    _B_in = _B_setup()

    return {
        "A_x": _A_in["x"],
        "A_k_cache": _A_in["k_cache"],
        "A_v_cache": _A_in["v_cache"],
        "A_wq": _A_in["wq"],
        "A_wo": _A_in["wo"],
        "B_x": _B_in["x"],
        "B_w_gate": _B_in["w_gate"],
        "B_w_up": _B_in["w_up"],
        "B_w_down": _B_in["w_down"],
        "gate_w": _w((lambda *s: torch.randn(*s, dtype=torch.bfloat16) * 0.05)(512) * 16.0),
    }

def reference(A_x, A_k_cache, A_v_cache, A_wq, A_wo, B_x, B_w_gate, B_w_up, B_w_down, gate_w):
    def _A_ref(x, k_cache, v_cache, wq, wo):
        B, Sq, D = x.shape
        Hq, Dh = 32, 128
        Hkv = k_cache.shape[1]
        rep = Hq // Hkv
        q = (lambda x, *d: x.permute(*d))((x @ wq).reshape(B, Sq, Hq, Dh), 0, 2, 1, 3)
        k = (lambda x, n, axis: torch.repeat_interleave(x, n, dim=axis))(k_cache, rep, axis=1)
        v = (lambda x, n, axis: torch.repeat_interleave(x, n, dim=axis))(v_cache, rep, axis=1)
        scores = torch.einsum("bhqd,bhkd->bhqk", q, k) * (Dh ** -0.5)
        p = _softmax(scores, axis=-1)
        o = torch.einsum("bhqk,bhkd->bhqd", p, v)
        return (lambda x, *d: x.permute(*d))(o, 0, 2, 1, 3).reshape(B, Sq, Hq * Dh) @ wo

    def _B_ref(x, w_gate, w_up, w_down):
        g = torch.einsum("bsd,df->bsf", x, w_gate)
        u = torch.einsum("bsd,df->bsf", x, w_up)
        h = _sigmoid(g) * u
        return torch.einsum("bsf,fd->bsd", h, w_down)

    x = A_x
    g = _sigmoid((x * gate_w).sum(-1, keepdims=True))
    a = _A_ref(x, A_k_cache, A_v_cache, A_wq, A_wo)
    b = _B_ref(x, B_w_gate, B_w_up, B_w_down)
    return g * a + (1 - g) * b
```

```asm
; @launch grid=(256,1,1) block=(512,1,1) lds=149504
.amdgcn_target "amdgcn-amd-amdhsa--gfx950"
.text
.globl gated_mix__gqa_block_cached__glu_gated_glu__decode_kernel
.p2align 8
.type gated_mix__gqa_block_cached__glu_gated_glu__decode_kernel,@function
gated_mix__gqa_block_cached__glu_gated_glu__decode_kernel:
  s_cmp_ge_u32 s2, 256
  s_cbranch_scc1 L_end
  s_load_dwordx16 s[4:19], s[0:1], 0
  s_load_dwordx8 s[20:27], s[0:1], 64
  s_load_dwordx2 s[28:29], s[0:1], 96
  v_mov_b32 v240, v0
  v_and_b32 v241, 63, v0
  v_lshrrev_b32 v244, 6, v0
  v_lshrrev_b32 v242, 4, v241
  v_readfirstlane_b32 s60, v244
  v_and_b32 v243, 15, v241
  s_mov_b32 s83, 0
  s_mov_b32 s80, 0x05040100
  s_mov_b32 s81, 0x07060302
  s_mov_b32 s82, 0x3db504f3
  s_mov_b32 s31, 0x3fb8aa3b
  s_lshr_b32 s61, s2, 3
  s_and_b32 s61, s61, 7
  s_lshr_b32 s63, s2, 6
  s_and_b32 s64, s2, 7
  s_lshl_b32 s62, s63, 3
  s_add_u32 s62, s62, s64
  s_lshl_b32 s65, s63, 3
  s_add_u32 s65, s65, s61
  s_lshl_b32 s66, s65, 21
  s_lshl_b32 s67, s64, 18
  s_add_u32 s66, s66, s67
  s_lshl_b32 s67, s60, 15
  s_add_u32 s66, s66, s67
  s_lshl_b32 s77, s60, 14
  s_add_u32 s77, s77, 18432
  s_lshl_b32 s76, s65, 7
  s_add_u32 s76, s76, 0x310000
  v_and_b32 v246, 3, v243
  v_lshlrev_b32 v246, 2, v246
  v_lshrrev_b32 v247, 2, v243
  v_add_u32 v246, v246, v247
  v_lshlrev_b32 v246, 8, v246
  v_lshl_add_u32 v246, v242, 4, v246
  v_lshlrev_b32 v247, 4, v241
  v_mov_b32 v248, 0
  v_mov_b32 v249, 17664
  ds_write_b32 v249, v248
  ds_write_b32 v249, v248 offset:16
  s_waitcnt lgkmcnt(0)
  s_barrier
  s_mov_b32 s32, s6
  s_and_b32 s33, s7, 0xffff
  s_mov_b32 s34, 0x4000000
  s_mov_b32 s35, 0x00020000
  s_mov_b32 s36, s8
  s_and_b32 s37, s9, 0xffff
  s_mov_b32 s38, 0x4000000
  s_mov_b32 s39, 0x00020000
  s_mov_b32 s40, s28
  s_and_b32 s41, s29, 0xffff
  s_mov_b32 s42, 0x10000000
  s_mov_b32 s43, 0x00020000
  s_mov_b32 s44, s26
  s_and_b32 s45, s27, 0xffff
  s_mov_b32 s46, 0x100
  s_mov_b32 s47, 0x00020000
  s_mov_b32 s52, s4
  s_and_b32 s53, s5, 0xffff
  s_mov_b32 s54, 0x1000
  s_mov_b32 s55, 0x00020000
  s_mov_b32 s56, s24
  s_and_b32 s57, s25, 0xffff
  s_mov_b32 s58, 0x1000
  s_mov_b32 s59, 0x00020000
  s_cmp_eq_u32 s60, 0
  s_cbranch_scc1 L_stage1
  s_lshl_b32 s67, s2, 3
  s_add_u32 s67, s67, s60
  s_cmp_lg_u32 s67, 1
  s_cbranch_scc1 L_nopub
  s_memrealtime s[78:79]
  s_waitcnt lgkmcnt(0)
  s_or_b32 s78, s78, 1
  s_or_b32 s79, s79, 0x80000000
  v_mov_b32 v8, s78
  v_mov_b32 v9, s79
  v_mov_b32 v10, 0
  s_mov_b64 exec, 1
  buffer_store_dwordx2 v[8:9], v10, s[44:47], 0 offen sc1
  s_mov_b64 exec, -1
L_nopub:
  v_lshlrev_b32 v168, 2, v242
  v_xor_b32 v168, v168, v243
  v_lshlrev_b32 v168, 4, v168
  v_lshl_add_u32 v168, v242, 8, v168
  v_lshlrev_b32 v169, 2, v242
  v_add_u32 v169, 1, v169
  v_xor_b32 v169, v169, v243
  v_lshlrev_b32 v169, 4, v169
  v_lshl_add_u32 v169, v242, 8, v169
  v_lshlrev_b32 v170, 2, v242
  v_add_u32 v170, 2, v170
  v_xor_b32 v170, v170, v243
  v_lshlrev_b32 v170, 4, v170
  v_lshl_add_u32 v170, v242, 8, v170
  v_lshlrev_b32 v171, 2, v242
  v_add_u32 v171, 3, v171
  v_xor_b32 v171, v171, v243
  v_lshlrev_b32 v171, 4, v171
  v_lshl_add_u32 v171, v242, 8, v171
  v_and_b32 v252, 3, v243
  v_lshlrev_b32 v252, 2, v252
  v_lshrrev_b32 v253, 2, v243
  v_add_u32 v252, v252, v253
  v_lshlrev_b32 v252, 8, v252
  v_add_u32 v252, s77, v252
  v_add_u32 v172, 0, v242
  v_xor_b32 v172, v172, v243
  v_lshl_add_u32 v172, v172, 4, v252
  v_add_u32 v173, 4, v242
  v_xor_b32 v173, v173, v243
  v_lshl_add_u32 v173, v173, 4, v252
  v_add_u32 v174, 8, v242
  v_xor_b32 v174, v174, v243
  v_lshl_add_u32 v174, v174, 4, v252
  v_add_u32 v175, 12, v242
  v_xor_b32 v175, v175, v243
  v_lshl_add_u32 v175, v175, 4, v252
  v_mov_b32 v248, 17664
L_fwait:
  ds_read_b32 v249, v248
  s_waitcnt lgkmcnt(0)
  v_readfirstlane_b32 s67, v249
  s_cmp_ge_u32 s67, 1
  s_cbranch_scc1 L_fwait_done
  s_add_u32 s83, s83, 1
  s_cmp_gt_u32 s83, 0x400000
  s_cbranch_scc1 L_fwait_done
  s_sleep 1
  s_branch L_fwait
L_fwait_done:
  s_add_u32 s67, s66, 0
  s_add_u32 m0, s77, 0
  s_nop 0
  buffer_load_dwordx4 v168, s[32:35], s67 offen offset:0 nt lds
  buffer_load_dwordx4 v169, s[32:35], s67 offen offset:1024 nt lds
  buffer_load_dwordx4 v170, s[32:35], s67 offen offset:2048 nt lds
  buffer_load_dwordx4 v171, s[32:35], s67 offen offset:3072 nt lds
  s_add_u32 s67, s66, 4096
  s_add_u32 m0, s77, 4096
  s_nop 0
  buffer_load_dwordx4 v168, s[32:35], s67 offen offset:0 nt lds
  buffer_load_dwordx4 v169, s[32:35], s67 offen offset:1024 nt lds
  buffer_load_dwordx4 v170, s[32:35], s67 offen offset:2048 nt lds
  buffer_load_dwordx4 v171, s[32:35], s67 offen offset:3072 nt lds
  s_add_u32 s67, s66, 8192
  s_add_u32 m0, s77, 8192
  s_nop 0
  buffer_load_dwordx4 v168, s[32:35], s67 offen offset:0 nt lds
  buffer_load_dwordx4 v169, s[32:35], s67 offen offset:1024 nt lds
  buffer_load_dwordx4 v170, s[32:35], s67 offen offset:2048 nt lds
  buffer_load_dwordx4 v171, s[32:35], s67 offen offset:3072 nt lds
  s_add_u32 s67, s66, 12288
  s_add_u32 m0, s77, 12288
  s_nop 0
  buffer_load_dwordx4 v168, s[32:35], s67 offen offset:0 nt lds
  buffer_load_dwordx4 v169, s[32:35], s67 offen offset:1024 nt lds
  buffer_load_dwordx4 v170, s[32:35], s67 offen offset:2048 nt lds
  buffer_load_dwordx4 v171, s[32:35], s67 offen offset:3072 nt lds
  s_add_u32 s67, s66, 0
  buffer_load_dwordx4 v[0:3], v247, s[36:39], s67 offen offset:0 nt
  buffer_load_dwordx4 v[4:7], v247, s[36:39], s67 offen offset:1024 nt
  buffer_load_dwordx4 v[8:11], v247, s[36:39], s67 offen offset:2048 nt
  buffer_load_dwordx4 v[12:15], v247, s[36:39], s67 offen offset:3072 nt
  s_add_u32 s67, s66, 4096
  buffer_load_dwordx4 v[16:19], v247, s[36:39], s67 offen offset:0 nt
  buffer_load_dwordx4 v[20:23], v247, s[36:39], s67 offen offset:1024 nt
  buffer_load_dwordx4 v[24:27], v247, s[36:39], s67 offen offset:2048 nt
  buffer_load_dwordx4 v[28:31], v247, s[36:39], s67 offen offset:3072 nt
  s_add_u32 s67, s66, 8192
  buffer_load_dwordx4 v[32:35], v247, s[36:39], s67 offen offset:0 nt
  buffer_load_dwordx4 v[36:39], v247, s[36:39], s67 offen offset:1024 nt
  buffer_load_dwordx4 v[40:43], v247, s[36:39], s67 offen offset:2048 nt
  buffer_load_dwordx4 v[44:47], v247, s[36:39], s67 offen offset:3072 nt
  s_add_u32 s67, s66, 12288
  buffer_load_dwordx4 v[48:51], v247, s[36:39], s67 offen offset:0 nt
  buffer_load_dwordx4 v[52:55], v247, s[36:39], s67 offen offset:1024 nt
  buffer_load_dwordx4 v[56:59], v247, s[36:39], s67 offen offset:2048 nt
  buffer_load_dwordx4 v[60:63], v247, s[36:39], s67 offen offset:3072 nt
  s_add_u32 s67, s66, 16384
  buffer_load_dwordx4 v[64:67], v247, s[36:39], s67 offen offset:0 nt
  buffer_load_dwordx4 v[68:71], v247, s[36:39], s67 offen offset:1024 nt
  buffer_load_dwordx4 v[72:75], v247, s[36:39], s67 offen offset:2048 nt
  buffer_load_dwordx4 v[76:79], v247, s[36:39], s67 offen offset:3072 nt
  s_add_u32 s67, s66, 20480
  buffer_load_dwordx4 v[80:83], v247, s[36:39], s67 offen offset:0 nt
  buffer_load_dwordx4 v[84:87], v247, s[36:39], s67 offen offset:1024 nt
  buffer_load_dwordx4 v[88:91], v247, s[36:39], s67 offen offset:2048 nt
  buffer_load_dwordx4 v[92:95], v247, s[36:39], s67 offen offset:3072 nt
  v_mov_b32 v248, 17664
L_qwait:
  ds_read_b32 v249, v248
  s_waitcnt lgkmcnt(0)
  v_readfirstlane_b32 s67, v249
  s_cmp_ge_u32 s67, 2
  s_cbranch_scc1 L_qwait_done
  s_add_u32 s83, s83, 1
  s_cmp_gt_u32 s83, 0x400000
  s_cbranch_scc1 L_qwait_done
  s_sleep 1
  s_branch L_qwait
L_qwait_done:
  v_and_b32 v249, 3, v243
  v_lshlrev_b32 v249, 8, v249
  v_lshl_add_u32 v249, v242, 4, v249
  ds_read_b128 v[224:227], v249 offset:0
  ds_read_b128 v[228:231], v249 offset:64
  ds_read_b128 v[232:235], v249 offset:128
  ds_read_b128 v[236:239], v249 offset:192
  s_waitcnt vmcnt(36)
  ds_read_b128 v[128:131], v172 offset:0
  ds_read_b128 v[132:135], v173 offset:0
  ds_read_b128 v[136:139], v174 offset:0
  ds_read_b128 v[140:143], v175 offset:0
  s_waitcnt vmcnt(32)
  ds_read_b128 v[144:147], v172 offset:4096
  ds_read_b128 v[148:151], v173 offset:4096
  ds_read_b128 v[152:155], v174 offset:4096
  ds_read_b128 v[156:159], v175 offset:4096
  s_waitcnt lgkmcnt(4)
  v_mfma_f32_16x16x32_bf16 v[192:195], v[128:131], v[224:227], 0
  v_mfma_f32_16x16x32_bf16 v[192:195], v[132:135], v[228:231], v[192:195]
  v_mfma_f32_16x16x32_bf16 v[192:195], v[136:139], v[232:235], v[192:195]
  v_mfma_f32_16x16x32_bf16 v[192:195], v[140:143], v[236:239], v[192:195]
  s_waitcnt vmcnt(28)
  ds_read_b128 v[128:131], v172 offset:8192
  ds_read_b128 v[132:135], v173 offset:8192
  ds_read_b128 v[136:139], v174 offset:8192
  ds_read_b128 v[140:143], v175 offset:8192
  s_waitcnt lgkmcnt(4)
  v_mfma_f32_16x16x32_bf16 v[196:199], v[144:147], v[224:227], 0
  v_mfma_f32_16x16x32_bf16 v[196:199], v[148:151], v[228:231], v[196:199]
  v_mfma_f32_16x16x32_bf16 v[196:199], v[152:155], v[232:235], v[196:199]
  v_mfma_f32_16x16x32_bf16 v[196:199], v[156:159], v[236:239], v[196:199]
  s_waitcnt vmcnt(24)
  ds_read_b128 v[144:147], v172 offset:12288
  ds_read_b128 v[148:151], v173 offset:12288
  ds_read_b128 v[152:155], v174 offset:12288
  ds_read_b128 v[156:159], v175 offset:12288
  s_waitcnt lgkmcnt(4)
  v_mfma_f32_16x16x32_bf16 v[200:203], v[128:131], v[224:227], 0
  v_mfma_f32_16x16x32_bf16 v[200:203], v[132:135], v[228:231], v[200:203]
  v_mfma_f32_16x16x32_bf16 v[200:203], v[136:139], v[232:235], v[200:203]
  v_mfma_f32_16x16x32_bf16 v[200:203], v[140:143], v[236:239], v[200:203]
  s_waitcnt lgkmcnt(0)
  v_mfma_f32_16x16x32_bf16 v[204:207], v[144:147], v[224:227], 0
  v_mfma_f32_16x16x32_bf16 v[204:207], v[148:151], v[228:231], v[204:207]
  v_mfma_f32_16x16x32_bf16 v[204:207], v[152:155], v[232:235], v[204:207]
  v_mfma_f32_16x16x32_bf16 v[204:207], v[156:159], v[236:239], v[204:207]
  s_add_u32 s67, s66, 16384
  s_add_u32 m0, s77, 0
  s_nop 0
  buffer_load_dwordx4 v168, s[32:35], s67 offen offset:0 nt lds
  buffer_load_dwordx4 v169, s[32:35], s67 offen offset:1024 nt lds
  buffer_load_dwordx4 v170, s[32:35], s67 offen offset:2048 nt lds
  buffer_load_dwordx4 v171, s[32:35], s67 offen offset:3072 nt lds
  s_add_u32 s67, s66, 20480
  s_add_u32 m0, s77, 4096
  s_nop 0
  buffer_load_dwordx4 v168, s[32:35], s67 offen offset:0 nt lds
  buffer_load_dwordx4 v169, s[32:35], s67 offen offset:1024 nt lds
  buffer_load_dwordx4 v170, s[32:35], s67 offen offset:2048 nt lds
  buffer_load_dwordx4 v171, s[32:35], s67 offen offset:3072 nt lds
  s_add_u32 s67, s66, 24576
  s_add_u32 m0, s77, 8192
  s_nop 0
  buffer_load_dwordx4 v168, s[32:35], s67 offen offset:0 nt lds
  buffer_load_dwordx4 v169, s[32:35], s67 offen offset:1024 nt lds
  buffer_load_dwordx4 v170, s[32:35], s67 offen offset:2048 nt lds
  buffer_load_dwordx4 v171, s[32:35], s67 offen offset:3072 nt lds
  s_add_u32 s67, s66, 28672
  s_add_u32 m0, s77, 12288
  s_nop 0
  buffer_load_dwordx4 v168, s[32:35], s67 offen offset:0 nt lds
  buffer_load_dwordx4 v169, s[32:35], s67 offen offset:1024 nt lds
  buffer_load_dwordx4 v170, s[32:35], s67 offen offset:2048 nt lds
  buffer_load_dwordx4 v171, s[32:35], s67 offen offset:3072 nt lds
  s_add_u32 s67, s66, 24576
  buffer_load_dwordx4 v[96:99], v247, s[36:39], s67 offen offset:0 nt
  buffer_load_dwordx4 v[100:103], v247, s[36:39], s67 offen offset:1024 nt
  buffer_load_dwordx4 v[104:107], v247, s[36:39], s67 offen offset:2048 nt
  buffer_load_dwordx4 v[108:111], v247, s[36:39], s67 offen offset:3072 nt
  s_add_u32 s67, s66, 28672
  buffer_load_dwordx4 v[112:115], v247, s[36:39], s67 offen offset:0 nt
  buffer_load_dwordx4 v[116:119], v247, s[36:39], s67 offen offset:1024 nt
  buffer_load_dwordx4 v[120:123], v247, s[36:39], s67 offen offset:2048 nt
  buffer_load_dwordx4 v[124:127], v247, s[36:39], s67 offen offset:3072 nt
  s_waitcnt vmcnt(20)
  v_mov_b32 v249, 17680
  v_mov_b32 v248, 1
  s_mov_b64 exec, 1
  ds_add_u32 v249, v248
  s_mov_b64 exec, -1
  s_waitcnt vmcnt(20)
  ds_read_b128 v[128:131], v172 offset:0
  ds_read_b128 v[132:135], v173 offset:0
  ds_read_b128 v[136:139], v174 offset:0
  ds_read_b128 v[140:143], v175 offset:0
  s_waitcnt vmcnt(16)
  ds_read_b128 v[144:147], v172 offset:4096
  ds_read_b128 v[148:151], v173 offset:4096
  ds_read_b128 v[152:155], v174 offset:4096
  ds_read_b128 v[156:159], v175 offset:4096
  s_waitcnt lgkmcnt(4)
  v_mfma_f32_16x16x32_bf16 v[208:211], v[128:131], v[224:227], 0
  v_mfma_f32_16x16x32_bf16 v[208:211], v[132:135], v[228:231], v[208:211]
  v_mfma_f32_16x16x32_bf16 v[208:211], v[136:139], v[232:235], v[208:211]
  v_mfma_f32_16x16x32_bf16 v[208:211], v[140:143], v[236:239], v[208:211]
  s_waitcnt vmcnt(12)
  ds_read_b128 v[128:131], v172 offset:8192
  ds_read_b128 v[132:135], v173 offset:8192
  ds_read_b128 v[136:139], v174 offset:8192
  ds_read_b128 v[140:143], v175 offset:8192
  s_waitcnt lgkmcnt(4)
  v_mfma_f32_16x16x32_bf16 v[212:215], v[144:147], v[224:227], 0
  v_mfma_f32_16x16x32_bf16 v[212:215], v[148:151], v[228:231], v[212:215]
  v_mfma_f32_16x16x32_bf16 v[212:215], v[152:155], v[232:235], v[212:215]
  v_mfma_f32_16x16x32_bf16 v[212:215], v[156:159], v[236:239], v[212:215]
  s_waitcnt vmcnt(8)
  ds_read_b128 v[144:147], v172 offset:12288
  ds_read_b128 v[148:151], v173 offset:12288
  ds_read_b128 v[152:155], v174 offset:12288
  ds_read_b128 v[156:159], v175 offset:12288
  s_waitcnt lgkmcnt(4)
  v_mfma_f32_16x16x32_bf16 v[216:219], v[128:131], v[224:227], 0
  v_mfma_f32_16x16x32_bf16 v[216:219], v[132:135], v[228:231], v[216:219]
  v_mfma_f32_16x16x32_bf16 v[216:219], v[136:139], v[232:235], v[216:219]
  v_mfma_f32_16x16x32_bf16 v[216:219], v[140:143], v[236:239], v[216:219]
  s_waitcnt lgkmcnt(0)
  v_mfma_f32_16x16x32_bf16 v[220:223], v[144:147], v[224:227], 0
  v_mfma_f32_16x16x32_bf16 v[220:223], v[148:151], v[228:231], v[220:223]
  v_mfma_f32_16x16x32_bf16 v[220:223], v[152:155], v[232:235], v[220:223]
  v_mfma_f32_16x16x32_bf16 v[220:223], v[156:159], v[236:239], v[220:223]
  s_nop 7
  v_max3_f32 v248, v192, v193, v194
  v_max3_f32 v248, v248, v195, v196
  v_max3_f32 v248, v248, v197, v198
  v_max3_f32 v248, v248, v199, v200
  v_max3_f32 v248, v248, v201, v202
  v_max3_f32 v248, v248, v203, v204
  v_max3_f32 v248, v248, v205, v206
  v_max3_f32 v248, v248, v207, v208
  v_max3_f32 v248, v248, v209, v210
  v_max3_f32 v248, v248, v211, v212
  v_max3_f32 v248, v248, v213, v214
  v_max3_f32 v248, v248, v215, v216
  v_max3_f32 v248, v248, v217, v218
  v_max3_f32 v248, v248, v219, v220
  v_max3_f32 v248, v248, v221, v222
  v_max_f32 v248, v248, v223
  v_mov_b32 v249, v248
  s_nop 1
  v_permlane16_swap_b32 v248, v249
  v_max_f32 v248, v248, v249
  v_mov_b32 v249, v248
  s_nop 1
  v_permlane32_swap_b32 v248, v249
  v_max_f32 v248, v248, v249
  v_cvt_pk_bf16_f32 v248, v248, v248
  v_lshlrev_b32 v248, 16, v248
  v_mul_f32 v248, s82, v248
  v_cvt_pk_bf16_f32 v248, v248, v248
  v_lshlrev_b32 v248, 16, v248
  v_mul_f32 v248, s31, v248
  v_cvt_pk_bf16_f32 v128, v192, v193
  v_cvt_pk_bf16_f32 v129, v194, v195
  v_cvt_pk_bf16_f32 v130, v196, v197
  v_cvt_pk_bf16_f32 v131, v198, v199
  v_cvt_pk_bf16_f32 v132, v200, v201
  v_cvt_pk_bf16_f32 v133, v202, v203
  v_cvt_pk_bf16_f32 v134, v204, v205
  v_cvt_pk_bf16_f32 v135, v206, v207
  v_cvt_pk_bf16_f32 v136, v208, v209
  v_cvt_pk_bf16_f32 v137, v210, v211
  v_cvt_pk_bf16_f32 v138, v212, v213
  v_cvt_pk_bf16_f32 v139, v214, v215
  v_cvt_pk_bf16_f32 v140, v216, v217
  v_cvt_pk_bf16_f32 v141, v218, v219
  v_cvt_pk_bf16_f32 v142, v220, v221
  v_cvt_pk_bf16_f32 v143, v222, v223
  v_lshlrev_b32 v192, 16, v128
  v_and_b32 v193, 0xffff0000, v128
  v_lshlrev_b32 v194, 16, v129
  v_and_b32 v195, 0xffff0000, v129
  v_lshlrev_b32 v196, 16, v130
  v_and_b32 v197, 0xffff0000, v130
  v_lshlrev_b32 v198, 16, v131
  v_and_b32 v199, 0xffff0000, v131
  v_lshlrev_b32 v200, 16, v132
  v_and_b32 v201, 0xffff0000, v132
  v_lshlrev_b32 v202, 16, v133
  v_and_b32 v203, 0xffff0000, v133
  v_lshlrev_b32 v204, 16, v134
  v_and_b32 v205, 0xffff0000, v134
  v_lshlrev_b32 v206, 16, v135
  v_and_b32 v207, 0xffff0000, v135
  v_lshlrev_b32 v208, 16, v136
  v_and_b32 v209, 0xffff0000, v136
  v_lshlrev_b32 v210, 16, v137
  v_and_b32 v211, 0xffff0000, v137
  v_lshlrev_b32 v212, 16, v138
  v_and_b32 v213, 0xffff0000, v138
  v_lshlrev_b32 v214, 16, v139
  v_and_b32 v215, 0xffff0000, v139
  v_lshlrev_b32 v216, 16, v140
  v_and_b32 v217, 0xffff0000, v140
  v_lshlrev_b32 v218, 16, v141
  v_and_b32 v219, 0xffff0000, v141
  v_lshlrev_b32 v220, 16, v142
  v_and_b32 v221, 0xffff0000, v142
  v_lshlrev_b32 v222, 16, v143
  v_and_b32 v223, 0xffff0000, v143
  v_mul_f32 v192, s82, v192
  v_mul_f32 v193, s82, v193
  v_mul_f32 v194, s82, v194
  v_mul_f32 v195, s82, v195
  v_mul_f32 v196, s82, v196
  v_mul_f32 v197, s82, v197
  v_mul_f32 v198, s82, v198
  v_mul_f32 v199, s82, v199
  v_mul_f32 v200, s82, v200
  v_mul_f32 v201, s82, v201
  v_mul_f32 v202, s82, v202
  v_mul_f32 v203, s82, v203
  v_mul_f32 v204, s82, v204
  v_mul_f32 v205, s82, v205
  v_mul_f32 v206, s82, v206
  v_mul_f32 v207, s82, v207
  v_mul_f32 v208, s82, v208
  v_mul_f32 v209, s82, v209
  v_mul_f32 v210, s82, v210
  v_mul_f32 v211, s82, v211
  v_mul_f32 v212, s82, v212
  v_mul_f32 v213, s82, v213
  v_mul_f32 v214, s82, v214
  v_mul_f32 v215, s82, v215
  v_mul_f32 v216, s82, v216
  v_mul_f32 v217, s82, v217
  v_mul_f32 v218, s82, v218
  v_mul_f32 v219, s82, v219
  v_mul_f32 v220, s82, v220
  v_mul_f32 v221, s82, v221
  v_mul_f32 v222, s82, v222
  v_mul_f32 v223, s82, v223
  v_cvt_pk_bf16_f32 v128, v192, v193
  v_cvt_pk_bf16_f32 v129, v194, v195
  v_cvt_pk_bf16_f32 v130, v196, v197
  v_cvt_pk_bf16_f32 v131, v198, v199
  v_cvt_pk_bf16_f32 v132, v200, v201
  v_cvt_pk_bf16_f32 v133, v202, v203
  v_cvt_pk_bf16_f32 v134, v204, v205
  v_cvt_pk_bf16_f32 v135, v206, v207
  v_cvt_pk_bf16_f32 v136, v208, v209
  v_cvt_pk_bf16_f32 v137, v210, v211
  v_cvt_pk_bf16_f32 v138, v212, v213
  v_cvt_pk_bf16_f32 v139, v214, v215
  v_cvt_pk_bf16_f32 v140, v216, v217
  v_cvt_pk_bf16_f32 v141, v218, v219
  v_cvt_pk_bf16_f32 v142, v220, v221
  v_cvt_pk_bf16_f32 v143, v222, v223
  v_lshlrev_b32 v192, 16, v128
  v_and_b32 v193, 0xffff0000, v128
  v_lshlrev_b32 v194, 16, v129
  v_and_b32 v195, 0xffff0000, v129
  v_lshlrev_b32 v196, 16, v130
  v_and_b32 v197, 0xffff0000, v130
  v_lshlrev_b32 v198, 16, v131
  v_and_b32 v199, 0xffff0000, v131
  v_lshlrev_b32 v200, 16, v132
  v_and_b32 v201, 0xffff0000, v132
  v_lshlrev_b32 v202, 16, v133
  v_and_b32 v203, 0xffff0000, v133
  v_lshlrev_b32 v204, 16, v134
  v_and_b32 v205, 0xffff0000, v134
  v_lshlrev_b32 v206, 16, v135
  v_and_b32 v207, 0xffff0000, v135
  v_lshlrev_b32 v208, 16, v136
  v_and_b32 v209, 0xffff0000, v136
  v_lshlrev_b32 v210, 16, v137
  v_and_b32 v211, 0xffff0000, v137
  v_lshlrev_b32 v212, 16, v138
  v_and_b32 v213, 0xffff0000, v138
  v_lshlrev_b32 v214, 16, v139
  v_and_b32 v215, 0xffff0000, v139
  v_lshlrev_b32 v216, 16, v140
  v_and_b32 v217, 0xffff0000, v140
  v_lshlrev_b32 v218, 16, v141
  v_and_b32 v219, 0xffff0000, v141
  v_lshlrev_b32 v220, 16, v142
  v_and_b32 v221, 0xffff0000, v142
  v_lshlrev_b32 v222, 16, v143
  v_and_b32 v223, 0xffff0000, v143
  v_fma_f32 v192, v192, s31, -v248
  v_fma_f32 v193, v193, s31, -v248
  v_fma_f32 v194, v194, s31, -v248
  v_fma_f32 v195, v195, s31, -v248
  v_fma_f32 v196, v196, s31, -v248
  v_fma_f32 v197, v197, s31, -v248
  v_fma_f32 v198, v198, s31, -v248
  v_fma_f32 v199, v199, s31, -v248
  v_fma_f32 v200, v200, s31, -v248
  v_fma_f32 v201, v201, s31, -v248
  v_fma_f32 v202, v202, s31, -v248
  v_fma_f32 v203, v203, s31, -v248
  v_fma_f32 v204, v204, s31, -v248
  v_fma_f32 v205, v205, s31, -v248
  v_fma_f32 v206, v206, s31, -v248
  v_fma_f32 v207, v207, s31, -v248
  v_fma_f32 v208, v208, s31, -v248
  v_fma_f32 v209, v209, s31, -v248
  v_fma_f32 v210, v210, s31, -v248
  v_fma_f32 v211, v211, s31, -v248
  v_fma_f32 v212, v212, s31, -v248
  v_fma_f32 v213, v213, s31, -v248
  v_fma_f32 v214, v214, s31, -v248
  v_fma_f32 v215, v215, s31, -v248
  v_fma_f32 v216, v216, s31, -v248
  v_fma_f32 v217, v217, s31, -v248
  v_fma_f32 v218, v218, s31, -v248
  v_fma_f32 v219, v219, s31, -v248
  v_fma_f32 v220, v220, s31, -v248
  v_fma_f32 v221, v221, s31, -v248
  v_fma_f32 v222, v222, s31, -v248
  v_fma_f32 v223, v223, s31, -v248
  v_exp_f32 v192, v192
  v_exp_f32 v193, v193
  v_exp_f32 v194, v194
  v_exp_f32 v195, v195
  v_exp_f32 v196, v196
  v_exp_f32 v197, v197
  v_exp_f32 v198, v198
  v_exp_f32 v199, v199
  v_exp_f32 v200, v200
  v_exp_f32 v201, v201
  v_exp_f32 v202, v202
  v_exp_f32 v203, v203
  v_exp_f32 v204, v204
  v_exp_f32 v205, v205
  v_exp_f32 v206, v206
  v_exp_f32 v207, v207
  v_exp_f32 v208, v208
  v_exp_f32 v209, v209
  v_exp_f32 v210, v210
  v_exp_f32 v211, v211
  v_exp_f32 v212, v212
  v_exp_f32 v213, v213
  v_exp_f32 v214, v214
  v_exp_f32 v215, v215
  v_exp_f32 v216, v216
  v_exp_f32 v217, v217
  v_exp_f32 v218, v218
  v_exp_f32 v219, v219
  v_exp_f32 v220, v220
  v_exp_f32 v221, v221
  v_exp_f32 v222, v222
  v_exp_f32 v223, v223
  s_nop 0
  v_add_f32 v250, v192, v193
  v_add_f32 v250, v250, v194
  v_add_f32 v250, v250, v195
  v_add_f32 v250, v250, v196
  v_add_f32 v250, v250, v197
  v_add_f32 v250, v250, v198
  v_add_f32 v250, v250, v199
  v_add_f32 v250, v250, v200
  v_add_f32 v250, v250, v201
  v_add_f32 v250, v250, v202
  v_add_f32 v250, v250, v203
  v_add_f32 v250, v250, v204
  v_add_f32 v250, v250, v205
  v_add_f32 v250, v250, v206
  v_add_f32 v250, v250, v207
  v_add_f32 v250, v250, v208
  v_add_f32 v250, v250, v209
  v_add_f32 v250, v250, v210
  v_add_f32 v250, v250, v211
  v_add_f32 v250, v250, v212
  v_add_f32 v250, v250, v213
  v_add_f32 v250, v250, v214
  v_add_f32 v250, v250, v215
  v_add_f32 v250, v250, v216
  v_add_f32 v250, v250, v217
  v_add_f32 v250, v250, v218
  v_add_f32 v250, v250, v219
  v_add_f32 v250, v250, v220
  v_add_f32 v250, v250, v221
  v_add_f32 v250, v250, v222
  v_add_f32 v250, v250, v223
  v_cvt_pk_bf16_f32 v224, v192, v193
  v_cvt_pk_bf16_f32 v225, v194, v195
  v_cvt_pk_bf16_f32 v226, v196, v197
  v_cvt_pk_bf16_f32 v227, v198, v199
  v_cvt_pk_bf16_f32 v228, v200, v201
  v_cvt_pk_bf16_f32 v229, v202, v203
  v_cvt_pk_bf16_f32 v230, v204, v205
  v_cvt_pk_bf16_f32 v231, v206, v207
  v_cvt_pk_bf16_f32 v232, v208, v209
  v_cvt_pk_bf16_f32 v233, v210, v211
  v_cvt_pk_bf16_f32 v234, v212, v213
  v_cvt_pk_bf16_f32 v235, v214, v215
  v_cvt_pk_bf16_f32 v236, v216, v217
  v_cvt_pk_bf16_f32 v237, v218, v219
  v_cvt_pk_bf16_f32 v238, v220, v221
  v_cvt_pk_bf16_f32 v239, v222, v223
  v_mov_b32 v249, v250
  s_nop 1
  v_permlane16_swap_b32 v250, v249
  v_add_f32 v250, v250, v249
  v_mov_b32 v249, v250
  s_nop 1
  v_permlane32_swap_b32 v250, v249
  v_add_f32 v250, v250, v249
  v_perm_b32 v160, v4, v0, s80
  v_perm_b32 v161, v12, v8, s80
  v_perm_b32 v162, v20, v16, s80
  v_perm_b32 v163, v28, v24, s80
  v_perm_b32 v164, v4, v0, s81
  v_perm_b32 v165, v12, v8, s81
  v_perm_b32 v166, v20, v16, s81
  v_perm_b32 v167, v28, v24, s81
  v_mfma_f32_16x16x32_bf16 v[192:195], v[224:227], v[160:163], 0
  v_perm_b32 v160, v5, v1, s80
  v_perm_b32 v161, v13, v9, s80
  v_perm_b32 v162, v21, v17, s80
  v_perm_b32 v163, v29, v25, s80
  v_mfma_f32_16x16x32_bf16 v[196:199], v[224:227], v[164:167], 0
  v_perm_b32 v164, v5, v1, s81
  v_perm_b32 v165, v13, v9, s81
  v_perm_b32 v166, v21, v17, s81
  v_perm_b32 v167, v29, v25, s81
  v_mfma_f32_16x16x32_bf16 v[200:203], v[224:227], v[160:163], 0
  v_perm_b32 v160, v6, v2, s80
  v_perm_b32 v161, v14, v10, s80
  v_perm_b32 v162, v22, v18, s80
  v_perm_b32 v163, v30, v26, s80
  v_mfma_f32_16x16x32_bf16 v[204:207], v[224:227], v[164:167], 0
  v_perm_b32 v164, v6, v2, s81
  v_perm_b32 v165, v14, v10, s81
  v_perm_b32 v166, v22, v18, s81
  v_perm_b32 v167, v30, v26, s81
  v_mfma_f32_16x16x32_bf16 v[208:211], v[224:227], v[160:163], 0
  v_perm_b32 v160, v7, v3, s80
  v_perm_b32 v161, v15, v11, s80
  v_perm_b32 v162, v23, v19, s80
  v_perm_b32 v163, v31, v27, s80
  v_mfma_f32_16x16x32_bf16 v[212:215], v[224:227], v[164:167], 0
  v_perm_b32 v164, v7, v3, s81
  v_perm_b32 v165, v15, v11, s81
  v_perm_b32 v166, v23, v19, s81
  v_perm_b32 v167, v31, v27, s81
  v_mfma_f32_16x16x32_bf16 v[216:219], v[224:227], v[160:163], 0
  s_nop 1
  v_mfma_f32_16x16x32_bf16 v[220:223], v[224:227], v[164:167], 0
  v_perm_b32 v160, v36, v32, s80
  v_perm_b32 v161, v44, v40, s80
  v_perm_b32 v162, v52, v48, s80
  v_perm_b32 v163, v60, v56, s80
  v_perm_b32 v164, v36, v32, s81
  v_perm_b32 v165, v44, v40, s81
  v_perm_b32 v166, v52, v48, s81
  v_perm_b32 v167, v60, v56, s81
  v_mfma_f32_16x16x32_bf16 v[192:195], v[228:231], v[160:163], v[192:195]
  v_perm_b32 v160, v37, v33, s80
  v_perm_b32 v161, v45, v41, s80
  v_perm_b32 v162, v53, v49, s80
  v_perm_b32 v163, v61, v57, s80
  v_mfma_f32_16x16x32_bf16 v[196:199], v[228:231], v[164:167], v[196:199]
  v_perm_b32 v164, v37, v33, s81
  v_perm_b32 v165, v45, v41, s81
  v_perm_b32 v166, v53, v49, s81
  v_perm_b32 v167, v61, v57, s81
  v_mfma_f32_16x16x32_bf16 v[200:203], v[228:231], v[160:163], v[200:203]
  v_perm_b32 v160, v38, v34, s80
  v_perm_b32 v161, v46, v42, s80
  v_perm_b32 v162, v54, v50, s80
  v_perm_b32 v163, v62, v58, s80
  v_mfma_f32_16x16x32_bf16 v[204:207], v[228:231], v[164:167], v[204:207]
  v_perm_b32 v164, v38, v34, s81
  v_perm_b32 v165, v46, v42, s81
  v_perm_b32 v166, v54, v50, s81
  v_perm_b32 v167, v62, v58, s81
  v_mfma_f32_16x16x32_bf16 v[208:211], v[228:231], v[160:163], v[208:211]
  v_perm_b32 v160, v39, v35, s80
  v_perm_b32 v161, v47, v43, s80
  v_perm_b32 v162, v55, v51, s80
  v_perm_b32 v163, v63, v59, s80
  v_mfma_f32_16x16x32_bf16 v[212:215], v[228:231], v[164:167], v[212:215]
  v_perm_b32 v164, v39, v35, s81
  v_perm_b32 v165, v47, v43, s81
  v_perm_b32 v166, v55, v51, s81
  v_perm_b32 v167, v63, v59, s81
  v_mfma_f32_16x16x32_bf16 v[216:219], v[228:231], v[160:163], v[216:219]
  s_nop 1
  v_mfma_f32_16x16x32_bf16 v[220:223], v[228:231], v[164:167], v[220:223]
  v_perm_b32 v160, v68, v64, s80
  v_perm_b32 v161, v76, v72, s80
  v_perm_b32 v162, v84, v80, s80
  v_perm_b32 v163, v92, v88, s80
  v_perm_b32 v164, v68, v64, s81
  v_perm_b32 v165, v76, v72, s81
  v_perm_b32 v166, v84, v80, s81
  v_perm_b32 v167, v92, v88, s81
  v_mfma_f32_16x16x32_bf16 v[192:195], v[232:235], v[160:163], v[192:195]
  v_perm_b32 v160, v69, v65, s80
  v_perm_b32 v161, v77, v73, s80
  v_perm_b32 v162, v85, v81, s80
  v_perm_b32 v163, v93, v89, s80
  v_mfma_f32_16x16x32_bf16 v[196:199], v[232:235], v[164:167], v[196:199]
  v_perm_b32 v164, v69, v65, s81
  v_perm_b32 v165, v77, v73, s81
  v_perm_b32 v166, v85, v81, s81
  v_perm_b32 v167, v93, v89, s81
  v_mfma_f32_16x16x32_bf16 v[200:203], v[232:235], v[160:163], v[200:203]
  v_perm_b32 v160, v70, v66, s80
  v_perm_b32 v161, v78, v74, s80
  v_perm_b32 v162, v86, v82, s80
  v_perm_b32 v163, v94, v90, s80
  v_mfma_f32_16x16x32_bf16 v[204:207], v[232:235], v[164:167], v[204:207]
  v_perm_b32 v164, v70, v66, s81
  v_perm_b32 v165, v78, v74, s81
  v_perm_b32 v166, v86, v82, s81
  v_perm_b32 v167, v94, v90, s81
  v_mfma_f32_16x16x32_bf16 v[208:211], v[232:235], v[160:163], v[208:211]
  v_perm_b32 v160, v71, v67, s80
  v_perm_b32 v161, v79, v75, s80
  v_perm_b32 v162, v87, v83, s80
  v_perm_b32 v163, v95, v91, s80
  v_mfma_f32_16x16x32_bf16 v[212:215], v[232:235], v[164:167], v[212:215]
  v_perm_b32 v164, v71, v67, s81
  v_perm_b32 v165, v79, v75, s81
  v_perm_b32 v166, v87, v83, s81
  v_perm_b32 v167, v95, v91, s81
  v_mfma_f32_16x16x32_bf16 v[216:219], v[232:235], v[160:163], v[216:219]
  s_nop 1
  v_mfma_f32_16x16x32_bf16 v[220:223], v[232:235], v[164:167], v[220:223]
  s_waitcnt vmcnt(0)
  s_cmp_eq_u32 s60, 5
  s_cbranch_scc1 L_pf_wo
  s_cmp_eq_u32 s60, 6
  s_cbranch_scc0 L_pf_done
  s_cmp_ge_u32 s2, 112
  s_cbranch_scc1 L_pf_done
  s_mov_b32 s48, s20
  s_and_b32 s49, s21, 0xffff
  s_mov_b32 s50, 0x1c0000
  s_mov_b32 s51, 0x00020000
  s_lshr_b32 s68, s2, 2
  s_lshl_b32 s68, s68, 16
  s_and_b32 s69, s2, 3
  s_branch L_pf_go
L_pf_wo:
  s_mov_b32 s48, s12
  s_and_b32 s49, s13, 0xffff
  s_mov_b32 s50, 0x400000
  s_mov_b32 s51, 0x00020000
  s_lshl_b32 s68, s61, 3
  s_lshr_b32 s69, s62, 2
  s_add_u32 s68, s68, s69
  s_lshl_b32 s68, s68, 16
  s_and_b32 s69, s62, 3
L_pf_go:
  s_lshl_b32 s69, s69, 8
  s_add_u32 s68, s68, s69
  v_lshlrev_b32 v251, 13, v242
  v_lshl_add_u32 v251, v243, 4, v251
  s_add_u32 s69, s68, 0
  buffer_load_dwordx4 v[128:131], v251, s[48:51], s69 offen offset:0 nt
  buffer_load_dwordx4 v[132:135], v251, s[48:51], s69 offen offset:1024 nt
  buffer_load_dwordx4 v[136:139], v251, s[48:51], s69 offen offset:2048 nt
  buffer_load_dwordx4 v[140:143], v251, s[48:51], s69 offen offset:3072 nt
  s_add_u32 s69, s68, 4096
  buffer_load_dwordx4 v[144:147], v251, s[48:51], s69 offen offset:0 nt
  buffer_load_dwordx4 v[148:151], v251, s[48:51], s69 offen offset:1024 nt
  buffer_load_dwordx4 v[152:155], v251, s[48:51], s69 offen offset:2048 nt
  buffer_load_dwordx4 v[156:159], v251, s[48:51], s69 offen offset:3072 nt
  s_add_u32 s69, s68, 32768
  buffer_load_dwordx4 v[160:163], v251, s[48:51], s69 offen offset:0 nt
  buffer_load_dwordx4 v[164:167], v251, s[48:51], s69 offen offset:1024 nt
  buffer_load_dwordx4 v[168:171], v251, s[48:51], s69 offen offset:2048 nt
  buffer_load_dwordx4 v[172:175], v251, s[48:51], s69 offen offset:3072 nt
  s_add_u32 s69, s68, 36864
  buffer_load_dwordx4 v[176:179], v251, s[48:51], s69 offen offset:0 nt
  buffer_load_dwordx4 v[180:183], v251, s[48:51], s69 offen offset:1024 nt
  buffer_load_dwordx4 v[184:187], v251, s[48:51], s69 offen offset:2048 nt
  buffer_load_dwordx4 v[188:191], v251, s[48:51], s69 offen offset:3072 nt
L_pf_done:
  v_perm_b32 v0, v100, v96, s80
  v_perm_b32 v1, v108, v104, s80
  v_perm_b32 v2, v116, v112, s80
  v_perm_b32 v3, v124, v120, s80
  v_perm_b32 v4, v100, v96, s81
  v_perm_b32 v5, v108, v104, s81
  v_perm_b32 v6, v116, v112, s81
  v_perm_b32 v7, v124, v120, s81
  v_mfma_f32_16x16x32_bf16 v[192:195], v[236:239], v[0:3], v[192:195]
  v_perm_b32 v0, v101, v97, s80
  v_perm_b32 v1, v109, v105, s80
  v_perm_b32 v2, v117, v113, s80
  v_perm_b32 v3, v125, v121, s80
  v_mfma_f32_16x16x32_bf16 v[196:199], v[236:239], v[4:7], v[196:199]
  v_perm_b32 v4, v101, v97, s81
  v_perm_b32 v5, v109, v105, s81
  v_perm_b32 v6, v117, v113, s81
  v_perm_b32 v7, v125, v121, s81
  v_mfma_f32_16x16x32_bf16 v[200:203], v[236:239], v[0:3], v[200:203]
  v_perm_b32 v0, v102, v98, s80
  v_perm_b32 v1, v110, v106, s80
  v_perm_b32 v2, v118, v114, s80
  v_perm_b32 v3, v126, v122, s80
  v_mfma_f32_16x16x32_bf16 v[204:207], v[236:239], v[4:7], v[204:207]
  v_perm_b32 v4, v102, v98, s81
  v_perm_b32 v5, v110, v106, s81
  v_perm_b32 v6, v118, v114, s81
  v_perm_b32 v7, v126, v122, s81
  v_mfma_f32_16x16x32_bf16 v[208:211], v[236:239], v[0:3], v[208:211]
  v_perm_b32 v0, v103, v99, s80
  v_perm_b32 v1, v111, v107, s80
  v_perm_b32 v2, v119, v115, s80
  v_perm_b32 v3, v127, v123, s80
  v_mfma_f32_16x16x32_bf16 v[212:215], v[236:239], v[4:7], v[212:215]
  v_perm_b32 v4, v103, v99, s81
  v_perm_b32 v5, v111, v107, s81
  v_perm_b32 v6, v119, v115, s81
  v_perm_b32 v7, v127, v123, s81
  v_mfma_f32_16x16x32_bf16 v[216:219], v[236:239], v[0:3], v[216:219]
  s_nop 1
  v_mfma_f32_16x16x32_bf16 v[220:223], v[236:239], v[4:7], v[220:223]
  s_lshl_b32 s67, s60, 11
  v_lshlrev_b32 v251, 5, v243
  v_add_u32 v251, s67, v251
  s_nop 5
  v_mov_b32 v0, v192
  v_mov_b32 v1, v196
  v_mov_b32 v2, v200
  v_mov_b32 v3, v204
  v_mov_b32 v4, v208
  v_mov_b32 v5, v212
  v_mov_b32 v6, v216
  v_mov_b32 v7, v220
  v_mov_b32 v8, v193
  v_mov_b32 v9, v197
  v_mov_b32 v10, v201
  v_mov_b32 v11, v205
  v_mov_b32 v12, v209
  v_mov_b32 v13, v213
  v_mov_b32 v14, v217
  v_mov_b32 v15, v221
  v_mov_b32 v16, v194
  v_mov_b32 v17, v198
  v_mov_b32 v18, v202
  v_mov_b32 v19, v206
  v_mov_b32 v20, v210
  v_mov_b32 v21, v214
  v_mov_b32 v22, v218
  v_mov_b32 v23, v222
  v_mov_b32 v24, v195
  v_mov_b32 v25, v199
  v_mov_b32 v26, v203
  v_mov_b32 v27, v207
  v_mov_b32 v28, v211
  v_mov_b32 v29, v215
  v_mov_b32 v30, v219
  v_mov_b32 v31, v223
  v_cmp_gt_u32 vcc, 16, v241
  s_nop 1
  s_and_saveexec_b64 s[70:71], vcc
  ds_write_b128 v251, v[0:3] offset:1024
  ds_write_b128 v251, v[4:7] offset:1040
  ds_write_b128 v251, v[8:11] offset:1536
  ds_write_b128 v251, v[12:15] offset:1552
  ds_write_b128 v251, v[16:19] offset:2048
  ds_write_b128 v251, v[20:23] offset:2064
  ds_write_b128 v251, v[24:27] offset:2560
  ds_write_b128 v251, v[28:31] offset:2576
  s_mov_b64 exec, s[70:71]
  s_lshl_b32 s67, s60, 5
  v_lshlrev_b32 v251, 3, v241
  v_add_u32 v251, s67, v251
  v_mov_b32 v252, v248
  v_mov_b32 v253, v250
  v_cmp_gt_u32 vcc, 4, v241
  s_nop 1
  s_and_saveexec_b64 s[70:71], vcc
  ds_write_b64 v251, v[252:253] offset:17408
  s_mov_b64 exec, s[70:71]
  s_waitcnt lgkmcnt(0)
  s_cmp_lt_u32 s60, 2
  s_cbranch_scc1 L_pool
L_w0done:
  s_cmp_eq_u32 s60, 3
  s_cbranch_scc0 L_noall
  v_mov_b32 v0, 17672
  ds_read_b64 v[2:3], v0
  v_lshlrev_b32 v1, 7, v241
  s_mov_b32 s68, 0x300000
  s_waitcnt lgkmcnt(0)
L_pollA:
  buffer_load_dwordx2 v[8:9], v1, s[40:43], s68 offen sc1
  s_add_u32 s69, s68, 8192
  buffer_load_dwordx2 v[10:11], v1, s[40:43], s69 offen sc1
  s_add_u32 s69, s68, 16384
  buffer_load_dwordx2 v[12:13], v1, s[40:43], s69 offen sc1
  s_add_u32 s69, s68, 24576
  buffer_load_dwordx2 v[14:15], v1, s[40:43], s69 offen sc1
  s_waitcnt vmcnt(0)
  v_xor_b32 v4, v8, v2
  v_xor_b32 v5, v9, v3
  v_or_b32 v4, v4, v5
  v_xor_b32 v5, v10, v2
  v_or_b32 v4, v4, v5
  v_xor_b32 v5, v11, v3
  v_or_b32 v4, v4, v5
  v_xor_b32 v5, v12, v2
  v_or_b32 v4, v4, v5
  v_xor_b32 v5, v13, v3
  v_or_b32 v4, v4, v5
  v_xor_b32 v5, v14, v2
  v_or_b32 v4, v4, v5
  v_xor_b32 v5, v15, v3
  v_or_b32 v4, v4, v5
  v_cmp_ne_u32 vcc, 0, v4
  s_nop 1
  s_cmp_eq_u64 vcc, 0
  s_cbranch_scc1 L_noall
  s_add_u32 s83, s83, 1
  s_cmp_gt_u32 s83, 0x40000
  s_cbranch_scc1 L_noall
  s_sleep 4
  s_branch L_pollA
L_noall:
  s_barrier
  s_sub_u32 s67, s60, 2
  s_cmp_ge_u32 s67, 2
  s_cbranch_scc1 L_nocomb
  v_subrev_u32 v1, 128, v240
  v_lshrrev_b32 v0, 5, v1
  v_lshlrev_b32 v2, 3, v0
  v_lshlrev_b32 v3, 4, v1
  ds_read_b64 v[8:9], v2 offset:17408
  ds_read_b64 v[10:11], v2 offset:17440
  ds_read_b64 v[12:13], v2 offset:17472
  ds_read_b64 v[14:15], v2 offset:17504
  ds_read_b64 v[16:17], v2 offset:17536
  ds_read_b64 v[18:19], v2 offset:17568
  ds_read_b64 v[20:21], v2 offset:17600
  ds_read_b64 v[22:23], v2 offset:17632
  ds_read_b128 v[24:27], v3 offset:1024
  ds_read_b128 v[28:31], v3 offset:3072
  ds_read_b128 v[32:35], v3 offset:5120
  ds_read_b128 v[36:39], v3 offset:7168
  ds_read_b128 v[40:43], v3 offset:9216
  ds_read_b128 v[44:47], v3 offset:11264
  ds_read_b128 v[48:51], v3 offset:13312
  ds_read_b128 v[52:55], v3 offset:15360
  s_waitcnt lgkmcnt(8)
  v_max3_f32 v4, v8, v10, v12
  v_max3_f32 v4, v4, v14, v16
  v_max3_f32 v4, v4, v18, v20
  v_max_f32 v4, v4, v22
  v_sub_f32 v8, v8, v4
  v_sub_f32 v10, v10, v4
  v_sub_f32 v12, v12, v4
  v_sub_f32 v14, v14, v4
  v_sub_f32 v16, v16, v4
  v_sub_f32 v18, v18, v4
  v_sub_f32 v20, v20, v4
  v_sub_f32 v22, v22, v4
  v_exp_f32 v8, v8
  v_exp_f32 v10, v10
  v_exp_f32 v12, v12
  v_exp_f32 v14, v14
  v_exp_f32 v16, v16
  v_exp_f32 v18, v18
  v_exp_f32 v20, v20
  v_exp_f32 v22, v22
  s_waitcnt lgkmcnt(0)
  v_mul_f32 v5, v8, v9
  v_mul_f32 v60, v8, v24
  v_mul_f32 v61, v8, v25
  v_mul_f32 v62, v8, v26
  v_mul_f32 v63, v8, v27
  v_fmac_f32 v5, v10, v11
  v_fmac_f32 v60, v10, v28
  v_fmac_f32 v61, v10, v29
  v_fmac_f32 v62, v10, v30
  v_fmac_f32 v63, v10, v31
  v_fmac_f32 v5, v12, v13
  v_fmac_f32 v60, v12, v32
  v_fmac_f32 v61, v12, v33
  v_fmac_f32 v62, v12, v34
  v_fmac_f32 v63, v12, v35
  v_fmac_f32 v5, v14, v15
  v_fmac_f32 v60, v14, v36
  v_fmac_f32 v61, v14, v37
  v_fmac_f32 v62, v14, v38
  v_fmac_f32 v63, v14, v39
  v_fmac_f32 v5, v16, v17
  v_fmac_f32 v60, v16, v40
  v_fmac_f32 v61, v16, v41
  v_fmac_f32 v62, v16, v42
  v_fmac_f32 v63, v16, v43
  v_fmac_f32 v5, v18, v19
  v_fmac_f32 v60, v18, v44
  v_fmac_f32 v61, v18, v45
  v_fmac_f32 v62, v18, v46
  v_fmac_f32 v63, v18, v47
  v_fmac_f32 v5, v20, v21
  v_fmac_f32 v60, v20, v48
  v_fmac_f32 v61, v20, v49
  v_fmac_f32 v62, v20, v50
  v_fmac_f32 v63, v20, v51
  v_fmac_f32 v5, v22, v23
  v_fmac_f32 v60, v22, v52
  v_fmac_f32 v61, v22, v53
  v_fmac_f32 v62, v22, v54
  v_fmac_f32 v63, v22, v55
  v_min_u32 v4, 0xfffffffe, v4
  v_min_u32 v5, 0xfffffffe, v5
  v_min_u32 v60, 0xfffffffe, v60
  v_min_u32 v61, 0xfffffffe, v61
  v_min_u32 v62, 0xfffffffe, v62
  v_min_u32 v63, 0xfffffffe, v63
  s_lshl_b32 s67, s65, 5
  s_add_u32 s67, s67, s64
  s_mul_i32 s68, s67, 640
  s_add_u32 s68, s68, 0x100000
  v_and_b32 v1, 31, v1
  v_mul_u32_u24 v7, 5120, v0
  v_lshl_add_u32 v7, v1, 4, v7
  buffer_store_dwordx4 v[60:63], v7, s[40:43], s68 offen sc1
  s_mov_b32 exec_lo, 1
  s_mov_b32 exec_hi, 1
  buffer_store_dwordx2 v[4:5], v7, s[40:43], s68 offen offset:512 sc1
  s_mov_b64 exec, -1
L_nocomb:
  s_cmp_eq_u32 s60, 5
  s_cbranch_scc1 L_tail_wo
  s_cmp_eq_u32 s60, 7
  s_cbranch_scc1 L_tail_fin
  s_cmp_eq_u32 s60, 6
  s_cbranch_scc0 L_exit
  s_cmp_ge_u32 s2, 112
  s_cbranch_scc1 L_exit
  v_and_b32 v0, 3, v243
  v_lshrrev_b32 v1, 2, v243
  v_lshl_add_u32 v2, v1, 2, v0
  s_movk_i32 s67, 30720
  v_mul_lo_u32 v2, v2, s67
  v_lshl_add_u32 v2, v242, 4, v2
  s_lshr_b32 s68, s2, 2
  s_lshr_b32 s69, s68, 1
  s_lshl_b32 s69, s69, 9
  s_and_b32 s72, s68, 1
  s_lshl_b32 s72, s72, 7
  s_add_u32 s69, s69, s72
  s_add_u32 s69, s69, 16384
  s_add_u32 s72, s69, 7168
  buffer_load_dwordx4 v[8:11], v2, s[40:43], s69 offen offset:0 sc1
  buffer_load_dwordx4 v[12:15], v2, s[40:43], s69 offen offset:256 sc1
  buffer_load_dwordx4 v[24:27], v2, s[40:43], s72 offen offset:0 sc1
  buffer_load_dwordx4 v[28:31], v2, s[40:43], s72 offen offset:256 sc1
  buffer_load_dwordx4 v[16:19], v2, s[40:43], s69 offen offset:64 sc1
  buffer_load_dwordx4 v[20:23], v2, s[40:43], s69 offen offset:320 sc1
  buffer_load_dwordx4 v[32:35], v2, s[40:43], s72 offen offset:64 sc1
  buffer_load_dwordx4 v[36:39], v2, s[40:43], s72 offen offset:320 sc1
  v_lshlrev_b32 v3, 2, v0
  s_mov_b32 s73, 0x80000
  buffer_load_dword v4, v3, s[40:43], s73 offen sc1
  s_waitcnt vmcnt(0)
  v_add_f32_dpp v8, v8, v8 row_ror:4 row_mask:0xf bank_mask:0xf
  v_add_f32_dpp v9, v9, v9 row_ror:4 row_mask:0xf bank_mask:0xf
  v_add_f32_dpp v10, v10, v10 row_ror:4 row_mask:0xf bank_mask:0xf
  v_add_f32_dpp v11, v11, v11 row_ror:4 row_mask:0xf bank_mask:0xf
  v_add_f32_dpp v12, v12, v12 row_ror:4 row_mask:0xf bank_mask:0xf
  v_add_f32_dpp v13, v13, v13 row_ror:4 row_mask:0xf bank_mask:0xf
  v_add_f32_dpp v14, v14, v14 row_ror:4 row_mask:0xf bank_mask:0xf
  v_add_f32_dpp v15, v15, v15 row_ror:4 row_mask:0xf bank_mask:0xf
  v_add_f32_dpp v16, v16, v16 row_ror:4 row_mask:0xf bank_mask:0xf
  v_add_f32_dpp v17, v17, v17 row_ror:4 row_mask:0xf bank_mask:0xf
  v_add_f32_dpp v18, v18, v18 row_ror:4 row_mask:0xf bank_mask:0xf
  v_add_f32_dpp v19, v19, v19 row_ror:4 row_mask:0xf bank_mask:0xf
  v_add_f32_dpp v20, v20, v20 row_ror:4 row_mask:0xf bank_mask:0xf
  v_add_f32_dpp v21, v21, v21 row_ror:4 row_mask:0xf bank_mask:0xf
  v_add_f32_dpp v22, v22, v22 row_ror:4 row_mask:0xf bank_mask:0xf
  v_add_f32_dpp v23, v23, v23 row_ror:4 row_mask:0xf bank_mask:0xf
  v_add_f32_dpp v24, v24, v24 row_ror:4 row_mask:0xf bank_mask:0xf
  v_add_f32_dpp v25, v25, v25 row_ror:4 row_mask:0xf bank_mask:0xf
  v_add_f32_dpp v26, v26, v26 row_ror:4 row_mask:0xf bank_mask:0xf
  v_add_f32_dpp v27, v27, v27 row_ror:4 row_mask:0xf bank_mask:0xf
  v_add_f32_dpp v28, v28, v28 row_ror:4 row_mask:0xf bank_mask:0xf
  v_add_f32_dpp v29, v29, v29 row_ror:4 row_mask:0xf bank_mask:0xf
  v_add_f32_dpp v30, v30, v30 row_ror:4 row_mask:0xf bank_mask:0xf
  v_add_f32_dpp v31, v31, v31 row_ror:4 row_mask:0xf bank_mask:0xf
  v_add_f32_dpp v32, v32, v32 row_ror:4 row_mask:0xf bank_mask:0xf
  v_add_f32_dpp v33, v33, v33 row_ror:4 row_mask:0xf bank_mask:0xf
  v_add_f32_dpp v34, v34, v34 row_ror:4 row_mask:0xf bank_mask:0xf
  v_add_f32_dpp v35, v35, v35 row_ror:4 row_mask:0xf bank_mask:0xf
  v_add_f32_dpp v36, v36, v36 row_ror:4 row_mask:0xf bank_mask:0xf
  v_add_f32_dpp v37, v37, v37 row_ror:4 row_mask:0xf bank_mask:0xf
  v_add_f32_dpp v38, v38, v38 row_ror:4 row_mask:0xf bank_mask:0xf
  v_add_f32_dpp v39, v39, v39 row_ror:4 row_mask:0xf bank_mask:0xf
  v_add_f32_dpp v8, v8, v8 row_ror:8 row_mask:0xf bank_mask:0xf
  v_add_f32_dpp v9, v9, v9 row_ror:8 row_mask:0xf bank_mask:0xf
  v_add_f32_dpp v10, v10, v10 row_ror:8 row_mask:0xf bank_mask:0xf
  v_add_f32_dpp v11, v11, v11 row_ror:8 row_mask:0xf bank_mask:0xf
  v_add_f32_dpp v12, v12, v12 row_ror:8 row_mask:0xf bank_mask:0xf
  v_add_f32_dpp v13, v13, v13 row_ror:8 row_mask:0xf bank_mask:0xf
  v_add_f32_dpp v14, v14, v14 row_ror:8 row_mask:0xf bank_mask:0xf
  v_add_f32_dpp v15, v15, v15 row_ror:8 row_mask:0xf bank_mask:0xf
  v_add_f32_dpp v16, v16, v16 row_ror:8 row_mask:0xf bank_mask:0xf
  v_add_f32_dpp v17, v17, v17 row_ror:8 row_mask:0xf bank_mask:0xf
  v_add_f32_dpp v18, v18, v18 row_ror:8 row_mask:0xf bank_mask:0xf
  v_add_f32_dpp v19, v19, v19 row_ror:8 row_mask:0xf bank_mask:0xf
  v_add_f32_dpp v20, v20, v20 row_ror:8 row_mask:0xf bank_mask:0xf
  v_add_f32_dpp v21, v21, v21 row_ror:8 row_mask:0xf bank_mask:0xf
  v_add_f32_dpp v22, v22, v22 row_ror:8 row_mask:0xf bank_mask:0xf
  v_add_f32_dpp v23, v23, v23 row_ror:8 row_mask:0xf bank_mask:0xf
  v_add_f32_dpp v24, v24, v24 row_ror:8 row_mask:0xf bank_mask:0xf
  v_add_f32_dpp v25, v25, v25 row_ror:8 row_mask:0xf bank_mask:0xf
  v_add_f32_dpp v26, v26, v26 row_ror:8 row_mask:0xf bank_mask:0xf
  v_add_f32_dpp v27, v27, v27 row_ror:8 row_mask:0xf bank_mask:0xf
  v_add_f32_dpp v28, v28, v28 row_ror:8 row_mask:0xf bank_mask:0xf
  v_add_f32_dpp v29, v29, v29 row_ror:8 row_mask:0xf bank_mask:0xf
  v_add_f32_dpp v30, v30, v30 row_ror:8 row_mask:0xf bank_mask:0xf
  v_add_f32_dpp v31, v31, v31 row_ror:8 row_mask:0xf bank_mask:0xf
  v_add_f32_dpp v32, v32, v32 row_ror:8 row_mask:0xf bank_mask:0xf
  v_add_f32_dpp v33, v33, v33 row_ror:8 row_mask:0xf bank_mask:0xf
  v_add_f32_dpp v34, v34, v34 row_ror:8 row_mask:0xf bank_mask:0xf
  v_add_f32_dpp v35, v35, v35 row_ror:8 row_mask:0xf bank_mask:0xf
  v_add_f32_dpp v36, v36, v36 row_ror:8 row_mask:0xf bank_mask:0xf
  v_add_f32_dpp v37, v37, v37 row_ror:8 row_mask:0xf bank_mask:0xf
  v_add_f32_dpp v38, v38, v38 row_ror:8 row_mask:0xf bank_mask:0xf
  v_add_f32_dpp v39, v39, v39 row_ror:8 row_mask:0xf bank_mask:0xf
  v_sub_f32 v4, 1.0, v4
  v_cvt_pk_bf16_f32 v4, v4, v4
  v_lshlrev_b32 v4, 16, v4
  v_mul_f32 v8, 0xbfb8aa3b, v8
  v_mul_f32 v9, 0xbfb8aa3b, v9
  v_mul_f32 v10, 0xbfb8aa3b, v10
  v_mul_f32 v11, 0xbfb8aa3b, v11
  v_mul_f32 v12, 0xbfb8aa3b, v12
  v_mul_f32 v13, 0xbfb8aa3b, v13
  v_mul_f32 v14, 0xbfb8aa3b, v14
  v_mul_f32 v15, 0xbfb8aa3b, v15
  v_mul_f32 v16, 0xbfb8aa3b, v16
  v_mul_f32 v17, 0xbfb8aa3b, v17
  v_mul_f32 v18, 0xbfb8aa3b, v18
  v_mul_f32 v19, 0xbfb8aa3b, v19
  v_mul_f32 v20, 0xbfb8aa3b, v20
  v_mul_f32 v21, 0xbfb8aa3b, v21
  v_mul_f32 v22, 0xbfb8aa3b, v22
  v_mul_f32 v23, 0xbfb8aa3b, v23
  v_exp_f32 v8, v8
  v_exp_f32 v9, v9
  v_exp_f32 v10, v10
  v_exp_f32 v11, v11
  v_exp_f32 v12, v12
  v_exp_f32 v13, v13
  v_exp_f32 v14, v14
  v_exp_f32 v15, v15
  v_exp_f32 v16, v16
  v_exp_f32 v17, v17
  v_exp_f32 v18, v18
  v_exp_f32 v19, v19
  v_exp_f32 v20, v20
  v_exp_f32 v21, v21
  v_exp_f32 v22, v22
  v_exp_f32 v23, v23
  v_mul_f32 v24, v24, v4
  v_mul_f32 v25, v25, v4
  v_mul_f32 v26, v26, v4
  v_mul_f32 v27, v27, v4
  v_mul_f32 v28, v28, v4
  v_mul_f32 v29, v29, v4
  v_mul_f32 v30, v30, v4
  v_mul_f32 v31, v31, v4
  v_mul_f32 v32, v32, v4
  v_mul_f32 v33, v33, v4
  v_mul_f32 v34, v34, v4
  v_mul_f32 v35, v35, v4
  v_mul_f32 v36, v36, v4
  v_mul_f32 v37, v37, v4
  v_mul_f32 v38, v38, v4
  v_mul_f32 v39, v39, v4
  v_add_f32 v8, 1.0, v8
  v_add_f32 v9, 1.0, v9
  v_add_f32 v10, 1.0, v10
  v_add_f32 v11, 1.0, v11
  v_add_f32 v12, 1.0, v12
  v_add_f32 v13, 1.0, v13
  v_add_f32 v14, 1.0, v14
  v_add_f32 v15, 1.0, v15
  v_add_f32 v16, 1.0, v16
  v_add_f32 v17, 1.0, v17
  v_add_f32 v18, 1.0, v18
  v_add_f32 v19, 1.0, v19
  v_add_f32 v20, 1.0, v20
  v_add_f32 v21, 1.0, v21
  v_add_f32 v22, 1.0, v22
  v_add_f32 v23, 1.0, v23
  v_rcp_f32 v8, v8
  v_rcp_f32 v9, v9
  v_rcp_f32 v10, v10
  v_rcp_f32 v11, v11
  v_rcp_f32 v12, v12
  v_rcp_f32 v13, v13
  v_rcp_f32 v14, v14
  v_rcp_f32 v15, v15
  v_rcp_f32 v16, v16
  v_rcp_f32 v17, v17
  v_rcp_f32 v18, v18
  v_rcp_f32 v19, v19
  v_rcp_f32 v20, v20
  v_rcp_f32 v21, v21
  v_rcp_f32 v22, v22
  v_rcp_f32 v23, v23
  s_nop 0
  v_mul_f32 v8, v8, v24
  v_mul_f32 v9, v9, v25
  v_mul_f32 v10, v10, v26
  v_mul_f32 v11, v11, v27
  v_mul_f32 v12, v12, v28
  v_mul_f32 v13, v13, v29
  v_mul_f32 v14, v14, v30
  v_mul_f32 v15, v15, v31
  v_mul_f32 v16, v16, v32
  v_mul_f32 v17, v17, v33
  v_mul_f32 v18, v18, v34
  v_mul_f32 v19, v19, v35
  v_mul_f32 v20, v20, v36
  v_mul_f32 v21, v21, v37
  v_mul_f32 v22, v22, v38
  v_mul_f32 v23, v23, v39
  v_cvt_pk_bf16_f32 v40, v8, v9
  v_cvt_pk_bf16_f32 v41, v10, v11
  v_cvt_pk_bf16_f32 v42, v12, v13
  v_cvt_pk_bf16_f32 v43, v14, v15
  v_cvt_pk_bf16_f32 v44, v16, v17
  v_cvt_pk_bf16_f32 v45, v18, v19
  v_cvt_pk_bf16_f32 v46, v20, v21
  v_cvt_pk_bf16_f32 v47, v22, v23
  s_and_b32 s69, s2, 3
  s_mul_i32 s69, s69, 92
  s_lshr_b32 s68, s2, 2
  s_add_u32 s69, s69, s68
  s_add_u32 s69, s69, 64
  s_branch L_tail_mm
L_tail_wo:
  v_and_b32 v0, 3, v243
  v_lshrrev_b32 v1, 2, v243
  s_lshr_b32 s68, s62, 3
  s_lshl_b32 s69, s61, 2
  s_add_u32 s69, s69, s68
  s_mul_i32 s72, s69, 5120
  s_add_u32 s73, s72, 0x100200
  s_lshr_b32 s74, s62, 2
  s_and_b32 s74, s74, 1
  s_lshl_b32 s74, s74, 8
  s_add_u32 s72, s72, s74
  s_add_u32 s72, s72, 0x100000
  s_mov_b32 s75, 163840
  v_mul_lo_u32 v3, v0, s75
  v_mul_u32_u24 v2, 1280, v1
  v_add_u32 v2, v2, v3
  v_lshl_add_u32 v2, v242, 5, v2
  v_lshrrev_b32 v5, 2, v241
  v_mul_u32_u24 v5, 640, v5
  v_add_u32 v5, v5, v3
  v_lshlrev_b32 v6, 2, v0
  s_mov_b32 s74, 0x80000
  buffer_load_dword v4, v6, s[40:43], s74 offen sc1
  s_waitcnt vmcnt(0)
  v_perm_b32 v64, v132, v128, s80
  v_perm_b32 v65, v140, v136, s80
  v_perm_b32 v66, v148, v144, s80
  v_perm_b32 v67, v156, v152, s80
  v_perm_b32 v68, v132, v128, s81
  v_perm_b32 v69, v140, v136, s81
  v_perm_b32 v70, v148, v144, s81
  v_perm_b32 v71, v156, v152, s81
  v_perm_b32 v72, v133, v129, s80
  v_perm_b32 v73, v141, v137, s80
  v_perm_b32 v74, v149, v145, s80
  v_perm_b32 v75, v157, v153, s80
  v_perm_b32 v76, v133, v129, s81
  v_perm_b32 v77, v141, v137, s81
  v_perm_b32 v78, v149, v145, s81
  v_perm_b32 v79, v157, v153, s81
  v_perm_b32 v80, v134, v130, s80
  v_perm_b32 v81, v142, v138, s80
  v_perm_b32 v82, v150, v146, s80
  v_perm_b32 v83, v158, v154, s80
  v_perm_b32 v84, v134, v130, s81
  v_perm_b32 v85, v142, v138, s81
  v_perm_b32 v86, v150, v146, s81
  v_perm_b32 v87, v158, v154, s81
  v_perm_b32 v88, v135, v131, s80
  v_perm_b32 v89, v143, v139, s80
  v_perm_b32 v90, v151, v147, s80
  v_perm_b32 v91, v159, v155, s80
  v_perm_b32 v92, v135, v131, s81
  v_perm_b32 v93, v143, v139, s81
  v_perm_b32 v94, v151, v147, s81
  v_perm_b32 v95, v159, v155, s81
  v_perm_b32 v96, v164, v160, s80
  v_perm_b32 v97, v172, v168, s80
  v_perm_b32 v98, v180, v176, s80
  v_perm_b32 v99, v188, v184, s80
  v_perm_b32 v100, v164, v160, s81
  v_perm_b32 v101, v172, v168, s81
  v_perm_b32 v102, v180, v176, s81
  v_perm_b32 v103, v188, v184, s81
  v_perm_b32 v104, v165, v161, s80
  v_perm_b32 v105, v173, v169, s80
  v_perm_b32 v106, v181, v177, s80
  v_perm_b32 v107, v189, v185, s80
  v_perm_b32 v108, v165, v161, s81
  v_perm_b32 v109, v173, v169, s81
  v_perm_b32 v110, v181, v177, s81
  v_perm_b32 v111, v189, v185, s81
  v_perm_b32 v112, v166, v162, s80
  v_perm_b32 v113, v174, v170, s80
  v_perm_b32 v114, v182, v178, s80
  v_perm_b32 v115, v190, v186, s80
  v_perm_b32 v116, v166, v162, s81
  v_perm_b32 v117, v174, v170, s81
  v_perm_b32 v118, v182, v178, s81
  v_perm_b32 v119, v190, v186, s81
  v_perm_b32 v120, v167, v163, s80
  v_perm_b32 v121, v175, v171, s80
  v_perm_b32 v122, v183, v179, s80
  v_perm_b32 v123, v191, v187, s80
  v_perm_b32 v124, v167, v163, s81
  v_perm_b32 v125, v175, v171, s81
  v_perm_b32 v126, v183, v179, s81
  v_perm_b32 v127, v191, v187, s81
  s_mov_b32 exec_hi, 0
L_poll1a:
  buffer_load_dwordx2 v[56:57], v5, s[40:43], s73 offen sc1
  s_waitcnt vmcnt(0)
  v_max_u32 v7, v56, v57
  v_cmp_eq_u32 vcc, -1, v7
  s_nop 1
  s_bcnt1_i32_b64 s74, vcc
  s_cmp_le_u32 s74, 4
  s_cbranch_scc1 L_poll1a_done
  s_add_u32 s83, s83, 1
  s_cmp_gt_u32 s83, 0x40000
  s_cbranch_scc1 L_poll1a_done
  s_sleep 1
  s_branch L_poll1a
L_poll1a_done:
  s_mov_b64 exec, -1
  v_mul_u32_u24 v5, 1280, v1
  v_add_u32 v5, v5, v3
L_poll1:
  buffer_load_dwordx4 v[8:11], v2, s[40:43], s72 offen offset:0 sc1
  buffer_load_dwordx4 v[12:15], v2, s[40:43], s72 offen offset:16 sc1
  buffer_load_dwordx4 v[16:19], v2, s[40:43], s72 offen offset:128 sc1
  buffer_load_dwordx4 v[20:23], v2, s[40:43], s72 offen offset:144 sc1
  buffer_load_dwordx4 v[24:27], v2, s[40:43], s72 offen offset:640 sc1
  buffer_load_dwordx4 v[28:31], v2, s[40:43], s72 offen offset:656 sc1
  buffer_load_dwordx4 v[32:35], v2, s[40:43], s72 offen offset:768 sc1
  buffer_load_dwordx4 v[36:39], v2, s[40:43], s72 offen offset:784 sc1
  buffer_load_dwordx2 v[40:41], v5, s[40:43], s73 offen sc1
  buffer_load_dwordx2 v[42:43], v5, s[40:43], s73 offen offset:640 sc1
  s_waitcnt vmcnt(0)
  v_max3_u32 v7, v8, v9, v10
  v_max3_u32 v7, v7, v11, v12
  v_max3_u32 v7, v7, v13, v14
  v_max3_u32 v7, v7, v15, v16
  v_max3_u32 v7, v7, v17, v18
  v_max3_u32 v7, v7, v19, v20
  v_max3_u32 v7, v7, v21, v22
  v_max3_u32 v7, v7, v23, v24
  v_max3_u32 v7, v7, v25, v26
  v_max3_u32 v7, v7, v27, v28
  v_max3_u32 v7, v7, v29, v30
  v_max3_u32 v7, v7, v31, v32
  v_max3_u32 v7, v7, v33, v34
  v_max3_u32 v7, v7, v35, v36
  v_max3_u32 v7, v7, v37, v38
  v_max3_u32 v7, v7, v39, v40
  v_max3_u32 v7, v7, v41, v42
  v_max_u32 v7, v7, v43
  v_cmp_eq_u32 vcc, -1, v7
  s_nop 1
  s_cmp_eq_u64 vcc, 0
  s_cbranch_scc1 L_poll1_done
  s_add_u32 s83, s83, 1
  s_cmp_gt_u32 s83, 0x40000
  s_cbranch_scc1 L_poll1_done
  s_mov_b64 exec, vcc
  s_branch L_poll1
L_poll1_done:
  s_mov_b64 exec, -1
  v_max_f32 v44, v40, v42
  s_nop 1
  v_max_f32_dpp v44, v44, v44 row_ror:4 row_mask:0xf bank_mask:0xf
  s_nop 1
  v_max_f32_dpp v44, v44, v44 row_ror:8 row_mask:0xf bank_mask:0xf
  v_sub_f32 v58, v40, v44
  v_sub_f32 v59, v42, v44
  v_exp_f32 v58, v58
  v_exp_f32 v59, v59
  s_nop 0
  v_mul_f32 v45, v58, v41
  v_fmac_f32 v45, v59, v43
  s_nop 1
  v_add_f32_dpp v45, v45, v45 row_ror:4 row_mask:0xf bank_mask:0xf
  s_nop 1
  v_add_f32_dpp v45, v45, v45 row_ror:8 row_mask:0xf bank_mask:0xf
  v_rcp_f32 v45, v45
  s_nop 0
  v_mul_f32 v45, v45, v4
  v_mul_f32 v58, v58, v45
  v_mul_f32 v59, v59, v45
  v_mul_f32 v8, v8, v58
  v_mul_f32 v9, v9, v58
  v_mul_f32 v10, v10, v58
  v_mul_f32 v11, v11, v58
  v_mul_f32 v12, v12, v58
  v_mul_f32 v13, v13, v58
  v_mul_f32 v14, v14, v58
  v_mul_f32 v15, v15, v58
  v_mul_f32 v16, v16, v58
  v_mul_f32 v17, v17, v58
  v_mul_f32 v18, v18, v58
  v_mul_f32 v19, v19, v58
  v_mul_f32 v20, v20, v58
  v_mul_f32 v21, v21, v58
  v_mul_f32 v22, v22, v58
  v_mul_f32 v23, v23, v58
  v_fmac_f32 v8, v24, v59
  v_fmac_f32 v9, v25, v59
  v_fmac_f32 v10, v26, v59
  v_fmac_f32 v11, v27, v59
  v_fmac_f32 v12, v28, v59
  v_fmac_f32 v13, v29, v59
  v_fmac_f32 v14, v30, v59
  v_fmac_f32 v15, v31, v59
  v_fmac_f32 v16, v32, v59
  v_fmac_f32 v17, v33, v59
  v_fmac_f32 v18, v34, v59
  v_fmac_f32 v19, v35, v59
  v_fmac_f32 v20, v36, v59
  v_fmac_f32 v21, v37, v59
  v_fmac_f32 v22, v38, v59
  v_fmac_f32 v23, v39, v59
  v_add_f32_dpp v8, v8, v8 row_ror:4 row_mask:0xf bank_mask:0xf
  v_add_f32_dpp v9, v9, v9 row_ror:4 row_mask:0xf bank_mask:0xf
  v_add_f32_dpp v10, v10, v10 row_ror:4 row_mask:0xf bank_mask:0xf
  v_add_f32_dpp v11, v11, v11 row_ror:4 row_mask:0xf bank_mask:0xf
  v_add_f32_dpp v12, v12, v12 row_ror:4 row_mask:0xf bank_mask:0xf
  v_add_f32_dpp v13, v13, v13 row_ror:4 row_mask:0xf bank_mask:0xf
  v_add_f32_dpp v14, v14, v14 row_ror:4 row_mask:0xf bank_mask:0xf
  v_add_f32_dpp v15, v15, v15 row_ror:4 row_mask:0xf bank_mask:0xf
  v_add_f32_dpp v16, v16, v16 row_ror:4 row_mask:0xf bank_mask:0xf
  v_add_f32_dpp v17, v17, v17 row_ror:4 row_mask:0xf bank_mask:0xf
  v_add_f32_dpp v18, v18, v18 row_ror:4 row_mask:0xf bank_mask:0xf
  v_add_f32_dpp v19, v19, v19 row_ror:4 row_mask:0xf bank_mask:0xf
  v_add_f32_dpp v20, v20, v20 row_ror:4 row_mask:0xf bank_mask:0xf
  v_add_f32_dpp v21, v21, v21 row_ror:4 row_mask:0xf bank_mask:0xf
  v_add_f32_dpp v22, v22, v22 row_ror:4 row_mask:0xf bank_mask:0xf
  v_add_f32_dpp v23, v23, v23 row_ror:4 row_mask:0xf bank_mask:0xf
  v_add_f32_dpp v8, v8, v8 row_ror:8 row_mask:0xf bank_mask:0xf
  v_add_f32_dpp v9, v9, v9 row_ror:8 row_mask:0xf bank_mask:0xf
  v_add_f32_dpp v10, v10, v10 row_ror:8 row_mask:0xf bank_mask:0xf
  v_add_f32_dpp v11, v11, v11 row_ror:8 row_mask:0xf bank_mask:0xf
  v_add_f32_dpp v12, v12, v12 row_ror:8 row_mask:0xf bank_mask:0xf
  v_add_f32_dpp v13, v13, v13 row_ror:8 row_mask:0xf bank_mask:0xf
  v_add_f32_dpp v14, v14, v14 row_ror:8 row_mask:0xf bank_mask:0xf
  v_add_f32_dpp v15, v15, v15 row_ror:8 row_mask:0xf bank_mask:0xf
  v_add_f32_dpp v16, v16, v16 row_ror:8 row_mask:0xf bank_mask:0xf
  v_add_f32_dpp v17, v17, v17 row_ror:8 row_mask:0xf bank_mask:0xf
  v_add_f32_dpp v18, v18, v18 row_ror:8 row_mask:0xf bank_mask:0xf
  v_add_f32_dpp v19, v19, v19 row_ror:8 row_mask:0xf bank_mask:0xf
  v_add_f32_dpp v20, v20, v20 row_ror:8 row_mask:0xf bank_mask:0xf
  v_add_f32_dpp v21, v21, v21 row_ror:8 row_mask:0xf bank_mask:0xf
  v_add_f32_dpp v22, v22, v22 row_ror:8 row_mask:0xf bank_mask:0xf
  v_add_f32_dpp v23, v23, v23 row_ror:8 row_mask:0xf bank_mask:0xf
  v_cvt_pk_bf16_f32 v40, v8, v9
  v_cvt_pk_bf16_f32 v41, v10, v11
  v_cvt_pk_bf16_f32 v42, v12, v13
  v_cvt_pk_bf16_f32 v43, v14, v15
  v_cvt_pk_bf16_f32 v44, v16, v17
  v_cvt_pk_bf16_f32 v45, v18, v19
  v_cvt_pk_bf16_f32 v46, v20, v21
  v_cvt_pk_bf16_f32 v47, v22, v23
  s_and_b32 s69, s62, 3
  s_mul_i32 s69, s69, 92
  s_lshl_b32 s68, s61, 3
  s_add_u32 s69, s69, s68
  s_lshr_b32 s68, s62, 2
  s_add_u32 s69, s69, s68
  v_mfma_f32_16x16x32_bf16 v[192:195], v[40:43], v[64:67], 0
  v_mfma_f32_16x16x32_bf16 v[196:199], v[40:43], v[68:71], 0
  v_mfma_f32_16x16x32_bf16 v[200:203], v[40:43], v[72:75], 0
  v_mfma_f32_16x16x32_bf16 v[204:207], v[40:43], v[76:79], 0
  v_mfma_f32_16x16x32_bf16 v[208:211], v[40:43], v[80:83], 0
  v_mfma_f32_16x16x32_bf16 v[212:215], v[40:43], v[84:87], 0
  v_mfma_f32_16x16x32_bf16 v[216:219], v[40:43], v[88:91], 0
  v_mfma_f32_16x16x32_bf16 v[220:223], v[40:43], v[92:95], 0
  v_mfma_f32_16x16x32_bf16 v[192:195], v[44:47], v[96:99], v[192:195]
  v_mfma_f32_16x16x32_bf16 v[196:199], v[44:47], v[100:103], v[196:199]
  v_mfma_f32_16x16x32_bf16 v[200:203], v[44:47], v[104:107], v[200:203]
  v_mfma_f32_16x16x32_bf16 v[204:207], v[44:47], v[108:111], v[204:207]
  v_mfma_f32_16x16x32_bf16 v[208:211], v[44:47], v[112:115], v[208:211]
  v_mfma_f32_16x16x32_bf16 v[212:215], v[44:47], v[116:119], v[212:215]
  v_mfma_f32_16x16x32_bf16 v[216:219], v[44:47], v[120:123], v[216:219]
  v_mfma_f32_16x16x32_bf16 v[220:223], v[44:47], v[124:127], v[220:223]
  s_branch L_tail_st
L_tail_mm:
  s_waitcnt vmcnt(0)
  v_perm_b32 v96, v132, v128, s80
  v_perm_b32 v97, v140, v136, s80
  v_perm_b32 v98, v148, v144, s80
  v_perm_b32 v99, v156, v152, s80
  v_perm_b32 v100, v132, v128, s81
  v_perm_b32 v101, v140, v136, s81
  v_perm_b32 v102, v148, v144, s81
  v_perm_b32 v103, v156, v152, s81
  v_mfma_f32_16x16x32_bf16 v[192:195], v[40:43], v[96:99], 0
  v_perm_b32 v96, v133, v129, s80
  v_perm_b32 v97, v141, v137, s80
  v_perm_b32 v98, v149, v145, s80
  v_perm_b32 v99, v157, v153, s80
  v_mfma_f32_16x16x32_bf16 v[196:199], v[40:43], v[100:103], 0
  v_perm_b32 v100, v133, v129, s81
  v_perm_b32 v101, v141, v137, s81
  v_perm_b32 v102, v149, v145, s81
  v_perm_b32 v103, v157, v153, s81
  v_mfma_f32_16x16x32_bf16 v[200:203], v[40:43], v[96:99], 0
  v_perm_b32 v96, v134, v130, s80
  v_perm_b32 v97, v142, v138, s80
  v_perm_b32 v98, v150, v146, s80
  v_perm_b32 v99, v158, v154, s80
  v_mfma_f32_16x16x32_bf16 v[204:207], v[40:43], v[100:103], 0
  v_perm_b32 v100, v134, v130, s81
  v_perm_b32 v101, v142, v138, s81
  v_perm_b32 v102, v150, v146, s81
  v_perm_b32 v103, v158, v154, s81
  v_mfma_f32_16x16x32_bf16 v[208:211], v[40:43], v[96:99], 0
  v_perm_b32 v96, v135, v131, s80
  v_perm_b32 v97, v143, v139, s80
  v_perm_b32 v98, v151, v147, s80
  v_perm_b32 v99, v159, v155, s80
  v_mfma_f32_16x16x32_bf16 v[212:215], v[40:43], v[100:103], 0
  v_perm_b32 v100, v135, v131, s81
  v_perm_b32 v101, v143, v139, s81
  v_perm_b32 v102, v151, v147, s81
  v_perm_b32 v103, v159, v155, s81
  v_mfma_f32_16x16x32_bf16 v[216:219], v[40:43], v[96:99], 0
  s_nop 1
  v_mfma_f32_16x16x32_bf16 v[220:223], v[40:43], v[100:103], 0
  v_perm_b32 v96, v164, v160, s80
  v_perm_b32 v97, v172, v168, s80
  v_perm_b32 v98, v180, v176, s80
  v_perm_b32 v99, v188, v184, s80
  v_perm_b32 v100, v164, v160, s81
  v_perm_b32 v101, v172, v168, s81
  v_perm_b32 v102, v180, v176, s81
  v_perm_b32 v103, v188, v184, s81
  v_mfma_f32_16x16x32_bf16 v[192:195], v[44:47], v[96:99], v[192:195]
  v_perm_b32 v96, v165, v161, s80
  v_perm_b32 v97, v173, v169, s80
  v_perm_b32 v98, v181, v177, s80
  v_perm_b32 v99, v189, v185, s80
  v_mfma_f32_16x16x32_bf16 v[196:199], v[44:47], v[100:103], v[196:199]
  v_perm_b32 v100, v165, v161, s81
  v_perm_b32 v101, v173, v169, s81
  v_perm_b32 v102, v181, v177, s81
  v_perm_b32 v103, v189, v185, s81
  v_mfma_f32_16x16x32_bf16 v[200:203], v[44:47], v[96:99], v[200:203]
  v_perm_b32 v96, v166, v162, s80
  v_perm_b32 v97, v174, v170, s80
  v_perm_b32 v98, v182, v178, s80
  v_perm_b32 v99, v190, v186, s80
  v_mfma_f32_16x16x32_bf16 v[204:207], v[44:47], v[100:103], v[204:207]
  v_perm_b32 v100, v166, v162, s81
  v_perm_b32 v101, v174, v170, s81
  v_perm_b32 v102, v182, v178, s81
  v_perm_b32 v103, v190, v186, s81
  v_mfma_f32_16x16x32_bf16 v[208:211], v[44:47], v[96:99], v[208:211]
  v_perm_b32 v96, v167, v163, s80
  v_perm_b32 v97, v175, v171, s80
  v_perm_b32 v98, v183, v179, s80
  v_perm_b32 v99, v191, v187, s80
  v_mfma_f32_16x16x32_bf16 v[212:215], v[44:47], v[100:103], v[212:215]
  v_perm_b32 v100, v167, v163, s81
  v_perm_b32 v101, v175, v171, s81
  v_perm_b32 v102, v183, v179, s81
  v_perm_b32 v103, v191, v187, s81
  v_mfma_f32_16x16x32_bf16 v[216:219], v[44:47], v[96:99], v[216:219]
  s_nop 1
  v_mfma_f32_16x16x32_bf16 v[220:223], v[44:47], v[100:103], v[220:223]
L_tail_st:
  s_lshl_b32 s69, s69, 11
  s_add_u32 s69, s69, 0x200000
  v_lshlrev_b32 v2, 4, v243
  v_cmp_gt_u32 vcc, 16, v241
  s_nop 4
  v_min_u32 v192, 0xfffffffe, v192
  v_min_u32 v193, 0xfffffffe, v193
  v_min_u32 v194, 0xfffffffe, v194
  v_min_u32 v195, 0xfffffffe, v195
  v_min_u32 v196, 0xfffffffe, v196
  v_min_u32 v197, 0xfffffffe, v197
  v_min_u32 v198, 0xfffffffe, v198
  v_min_u32 v199, 0xfffffffe, v199
  v_min_u32 v200, 0xfffffffe, v200
  v_min_u32 v201, 0xfffffffe, v201
  v_min_u32 v202, 0xfffffffe, v202
  v_min_u32 v203, 0xfffffffe, v203
  v_min_u32 v204, 0xfffffffe, v204
  v_min_u32 v205, 0xfffffffe, v205
  v_min_u32 v206, 0xfffffffe, v206
  v_min_u32 v207, 0xfffffffe, v207
  v_min_u32 v208, 0xfffffffe, v208
  v_min_u32 v209, 0xfffffffe, v209
  v_min_u32 v210, 0xfffffffe, v210
  v_min_u32 v211, 0xfffffffe, v211
  v_min_u32 v212, 0xfffffffe, v212
  v_min_u32 v213, 0xfffffffe, v213
  v_min_u32 v214, 0xfffffffe, v214
  v_min_u32 v215, 0xfffffffe, v215
  v_min_u32 v216, 0xfffffffe, v216
  v_min_u32 v217, 0xfffffffe, v217
  v_min_u32 v218, 0xfffffffe, v218
  v_min_u32 v219, 0xfffffffe, v219
  v_min_u32 v220, 0xfffffffe, v220
  v_min_u32 v221, 0xfffffffe, v221
  v_min_u32 v222, 0xfffffffe, v222
  v_min_u32 v223, 0xfffffffe, v223
  s_and_saveexec_b64 s[70:71], vcc
  buffer_store_dwordx4 v[192:195], v2, s[40:43], s69 offen offset:0 sc1
  buffer_store_dwordx4 v[196:199], v2, s[40:43], s69 offen offset:256 sc1
  buffer_store_dwordx4 v[200:203], v2, s[40:43], s69 offen offset:512 sc1
  buffer_store_dwordx4 v[204:207], v2, s[40:43], s69 offen offset:768 sc1
  buffer_store_dwordx4 v[208:211], v2, s[40:43], s69 offen offset:1024 sc1
  buffer_store_dwordx4 v[212:215], v2, s[40:43], s69 offen offset:1280 sc1
  buffer_store_dwordx4 v[216:219], v2, s[40:43], s69 offen offset:1536 sc1
  buffer_store_dwordx4 v[220:223], v2, s[40:43], s69 offen offset:1792 sc1
  s_mov_b64 exec, s[70:71]
  s_cmp_eq_u32 s60, 5
  s_cbranch_scc0 L_noflag3
  v_mov_b32 v2, 17664
  v_mov_b32 v3, 3
  ds_write_b32 v2, v3
L_noflag3:
  s_branch L_exit
L_tail_fin:
  v_lshrrev_b32 v0, 1, v241
  v_and_b32 v1, 1, v241
  s_lshr_b32 s68, s2, 6
  s_mul_i32 s68, s68, 188416
  s_and_b32 s69, s2, 3
  s_lshl_b32 s69, s69, 9
  s_add_u32 s68, s68, s69
  s_lshr_b32 s69, s2, 2
  s_and_b32 s69, s69, 15
  s_lshl_b32 s69, s69, 4
  s_add_u32 s68, s68, s69
  s_add_u32 s68, s68, 0x200000
  v_lshlrev_b32 v2, 11, v0
  v_lshl_add_u32 v2, v1, 8, v2
  s_add_u32 s69, s68, 65536
  v_cmp_gt_u32 vcc, 28, v0
  v_add_u32 v3, 0x20000, v2
  s_nop 0
  v_cndmask_b32 v3, v2, v3, vcc
  v_mov_b32 v20, 17664
L_finwait:
  ds_read_b32 v21, v20
  s_waitcnt lgkmcnt(0)
  v_readfirstlane_b32 s67, v21
  s_cmp_ge_u32 s67, 3
  s_cbranch_scc1 L_finwait_done
  s_add_u32 s83, s83, 1
  s_cmp_gt_u32 s83, 0x400000
  s_cbranch_scc1 L_finwait_done
  s_sleep 1
  s_branch L_finwait
L_finwait_done:
L_poll2:
  buffer_load_dwordx4 v[8:11], v2, s[40:43], s68 offen sc1
  buffer_load_dwordx4 v[12:15], v2, s[40:43], s69 offen sc1
  buffer_load_dwordx4 v[16:19], v3, s[40:43], s68 offen sc1
  s_waitcnt vmcnt(0)
  v_max3_u32 v7, v8, v9, v10
  v_max3_u32 v7, v7, v11, v12
  v_max3_u32 v7, v7, v13, v14
  v_max3_u32 v7, v7, v15, v16
  v_max3_u32 v7, v7, v17, v18
  v_max_u32 v7, v7, v19
  v_cmp_eq_u32 vcc, -1, v7
  s_nop 1
  s_cmp_eq_u64 vcc, 0
  s_cbranch_scc1 L_poll2_done
  s_add_u32 s83, s83, 1
  s_cmp_gt_u32 s83, 0x40000
  s_cbranch_scc1 L_poll2_done
  s_mov_b64 exec, vcc
  s_sleep 1
  s_branch L_poll2
L_poll2_done:
  s_mov_b64 exec, -1
  v_cmp_gt_u32 vcc, 28, v0
  s_nop 1
  v_cndmask_b32 v16, 0, v16, vcc
  v_cndmask_b32 v17, 0, v17, vcc
  v_cndmask_b32 v18, 0, v18, vcc
  v_cndmask_b32 v19, 0, v19, vcc
  v_add_f32 v8, v8, v12
  v_add_f32 v9, v9, v13
  v_add_f32 v10, v10, v14
  v_add_f32 v11, v11, v15
  v_add_f32 v8, v8, v16
  v_add_f32 v9, v9, v17
  v_add_f32 v10, v10, v18
  v_add_f32 v11, v11, v19
  s_nop 1
  v_add_f32_dpp v8, v8, v8 row_ror:2 row_mask:0xf bank_mask:0xf
  v_add_f32_dpp v9, v9, v9 row_ror:2 row_mask:0xf bank_mask:0xf
  v_add_f32_dpp v10, v10, v10 row_ror:2 row_mask:0xf bank_mask:0xf
  v_add_f32_dpp v11, v11, v11 row_ror:2 row_mask:0xf bank_mask:0xf
  s_nop 1
  v_add_f32_dpp v8, v8, v8 row_ror:4 row_mask:0xf bank_mask:0xf
  v_add_f32_dpp v9, v9, v9 row_ror:4 row_mask:0xf bank_mask:0xf
  v_add_f32_dpp v10, v10, v10 row_ror:4 row_mask:0xf bank_mask:0xf
  v_add_f32_dpp v11, v11, v11 row_ror:4 row_mask:0xf bank_mask:0xf
  s_nop 1
  v_add_f32_dpp v8, v8, v8 row_ror:8 row_mask:0xf bank_mask:0xf
  v_add_f32_dpp v9, v9, v9 row_ror:8 row_mask:0xf bank_mask:0xf
  v_add_f32_dpp v10, v10, v10 row_ror:8 row_mask:0xf bank_mask:0xf
  v_add_f32_dpp v11, v11, v11 row_ror:8 row_mask:0xf bank_mask:0xf
  v_mov_b32 v12, v8
  v_mov_b32 v13, v9
  v_mov_b32 v14, v10
  v_mov_b32 v15, v11
  s_nop 1
  v_permlane16_swap_b32 v8, v12
  v_permlane16_swap_b32 v9, v13
  v_permlane16_swap_b32 v10, v14
  v_permlane16_swap_b32 v11, v15
  v_add_f32 v8, v8, v12
  v_add_f32 v9, v9, v13
  v_add_f32 v10, v10, v14
  v_add_f32 v11, v11, v15
  v_mov_b32 v12, v8
  v_mov_b32 v13, v9
  v_mov_b32 v14, v10
  v_mov_b32 v15, v11
  s_nop 1
  v_permlane32_swap_b32 v8, v12
  v_permlane32_swap_b32 v9, v13
  v_permlane32_swap_b32 v10, v14
  v_permlane32_swap_b32 v11, v15
  v_add_f32 v8, v8, v12
  v_add_f32 v9, v9, v13
  v_add_f32 v10, v10, v14
  v_add_f32 v11, v11, v15
  s_nop 1
  v_mov_b32_dpp v12, v8 quad_perm:[1,0,3,2] row_mask:0xf bank_mask:0xf
  v_mov_b32_dpp v13, v9 quad_perm:[1,0,3,2] row_mask:0xf bank_mask:0xf
  v_mov_b32_dpp v14, v10 quad_perm:[1,0,3,2] row_mask:0xf bank_mask:0xf
  v_mov_b32_dpp v15, v11 quad_perm:[1,0,3,2] row_mask:0xf bank_mask:0xf
  v_cvt_pk_bf16_f32 v8, v8, v12
  v_cvt_pk_bf16_f32 v9, v9, v13
  v_cvt_pk_bf16_f32 v10, v10, v14
  v_cvt_pk_bf16_f32 v11, v11, v15
  s_lshl_b32 s68, s2, 2
  v_mov_b32 v2, 0
  s_mov_b64 exec, 1
  buffer_store_dword v8, v2, s[56:59], s68 offen offset:0
  buffer_store_dword v9, v2, s[56:59], s68 offen offset:1024
  buffer_store_dword v10, v2, s[56:59], s68 offen offset:2048
  buffer_store_dword v11, v2, s[56:59], s68 offen offset:3072
  s_mov_b64 exec, -1
L_exit:
L_end:
  s_endpgm
L_pool:
  v_mov_b32 v248, 17680
L_pwait:
  ds_read_b32 v249, v248
  s_waitcnt lgkmcnt(0)
  v_readfirstlane_b32 s67, v249
  s_cmp_ge_u32 s67, 7
  s_cbranch_scc1 L_pwait_done
  s_add_u32 s83, s83, 1
  s_cmp_gt_u32 s83, 0x400000
  s_cbranch_scc1 L_pwait_done
  s_sleep 1
  s_branch L_pwait
L_pwait_done:
L_pool_nogate:
  v_mov_b32 v254, 1
  v_mov_b32 v255, 0
  s_mov_b64 exec, 1
  buffer_atomic_add v254, v255, s[40:43], s76 offen sc0 sc1
  s_mov_b64 exec, -1
  s_waitcnt vmcnt(0)
L_claimed:
  v_readfirstlane_b32 s67, v254
  s_cmp_ge_u32 s67, 16
  s_cbranch_scc1 L_w0done
  s_lshl_b32 s66, s65, 21
  s_lshr_b32 s68, s67, 1
  s_lshl_b32 s68, s68, 18
  s_add_u32 s66, s66, s68
  s_and_b32 s68, s67, 1
  s_lshl_b32 s68, s68, 14
  s_add_u32 s66, s66, s68
  s_add_u32 s67, s66, 0
  s_add_u32 m0, s77, 0
  s_nop 0
  buffer_load_dwordx4 v168, s[32:35], s67 offen offset:0 nt lds
  buffer_load_dwordx4 v169, s[32:35], s67 offen offset:1024 nt lds
  buffer_load_dwordx4 v170, s[32:35], s67 offen offset:2048 nt lds
  buffer_load_dwordx4 v171, s[32:35], s67 offen offset:3072 nt lds
  s_add_u32 s67, s66, 4096
  s_add_u32 m0, s77, 4096
  s_nop 0
  buffer_load_dwordx4 v168, s[32:35], s67 offen offset:0 nt lds
  buffer_load_dwordx4 v169, s[32:35], s67 offen offset:1024 nt lds
  buffer_load_dwordx4 v170, s[32:35], s67 offen offset:2048 nt lds
  buffer_load_dwordx4 v171, s[32:35], s67 offen offset:3072 nt lds
  s_add_u32 s67, s66, 8192
  s_add_u32 m0, s77, 8192
  s_nop 0
  buffer_load_dwordx4 v168, s[32:35], s67 offen offset:0 nt lds
  buffer_load_dwordx4 v169, s[32:35], s67 offen offset:1024 nt lds
  buffer_load_dwordx4 v170, s[32:35], s67 offen offset:2048 nt lds
  buffer_load_dwordx4 v171, s[32:35], s67 offen offset:3072 nt lds
  s_add_u32 s67, s66, 12288
  s_add_u32 m0, s77, 12288
  s_nop 0
  buffer_load_dwordx4 v168, s[32:35], s67 offen offset:0 nt lds
  buffer_load_dwordx4 v169, s[32:35], s67 offen offset:1024 nt lds
  buffer_load_dwordx4 v170, s[32:35], s67 offen offset:2048 nt lds
  buffer_load_dwordx4 v171, s[32:35], s67 offen offset:3072 nt lds
  s_add_u32 s67, s66, 0
  buffer_load_dwordx4 v[0:3], v247, s[36:39], s67 offen offset:0 nt
  buffer_load_dwordx4 v[4:7], v247, s[36:39], s67 offen offset:1024 nt
  buffer_load_dwordx4 v[8:11], v247, s[36:39], s67 offen offset:2048 nt
  buffer_load_dwordx4 v[12:15], v247, s[36:39], s67 offen offset:3072 nt
  s_add_u32 s67, s66, 4096
  buffer_load_dwordx4 v[16:19], v247, s[36:39], s67 offen offset:0 nt
  buffer_load_dwordx4 v[20:23], v247, s[36:39], s67 offen offset:1024 nt
  buffer_load_dwordx4 v[24:27], v247, s[36:39], s67 offen offset:2048 nt
  buffer_load_dwordx4 v[28:31], v247, s[36:39], s67 offen offset:3072 nt
  s_add_u32 s67, s66, 8192
  buffer_load_dwordx4 v[32:35], v247, s[36:39], s67 offen offset:0 nt
  buffer_load_dwordx4 v[36:39], v247, s[36:39], s67 offen offset:1024 nt
  buffer_load_dwordx4 v[40:43], v247, s[36:39], s67 offen offset:2048 nt
  buffer_load_dwordx4 v[44:47], v247, s[36:39], s67 offen offset:3072 nt
  s_add_u32 s67, s66, 12288
  buffer_load_dwordx4 v[48:51], v247, s[36:39], s67 offen offset:0 nt
  buffer_load_dwordx4 v[52:55], v247, s[36:39], s67 offen offset:1024 nt
  buffer_load_dwordx4 v[56:59], v247, s[36:39], s67 offen offset:2048 nt
  buffer_load_dwordx4 v[60:63], v247, s[36:39], s67 offen offset:3072 nt
  v_and_b32 v249, 3, v243
  v_lshlrev_b32 v249, 8, v249
  v_lshl_add_u32 v249, v242, 4, v249
  ds_read_b128 v[224:227], v249 offset:0
  ds_read_b128 v[228:231], v249 offset:64
  ds_read_b128 v[232:235], v249 offset:128
  ds_read_b128 v[236:239], v249 offset:192
  s_waitcnt vmcnt(28)
  ds_read_b128 v[128:131], v172 offset:0
  ds_read_b128 v[132:135], v173 offset:0
  ds_read_b128 v[136:139], v174 offset:0
  ds_read_b128 v[140:143], v175 offset:0
  s_waitcnt vmcnt(24)
  ds_read_b128 v[144:147], v172 offset:4096
  ds_read_b128 v[148:151], v173 offset:4096
  ds_read_b128 v[152:155], v174 offset:4096
  ds_read_b128 v[156:159], v175 offset:4096
  s_waitcnt lgkmcnt(4)
  v_mfma_f32_16x16x32_bf16 v[192:195], v[128:131], v[224:227], 0
  v_mfma_f32_16x16x32_bf16 v[192:195], v[132:135], v[228:231], v[192:195]
  v_mfma_f32_16x16x32_bf16 v[192:195], v[136:139], v[232:235], v[192:195]
  v_mfma_f32_16x16x32_bf16 v[192:195], v[140:143], v[236:239], v[192:195]
  s_waitcnt vmcnt(20)
  ds_read_b128 v[128:131], v172 offset:8192
  ds_read_b128 v[132:135], v173 offset:8192
  ds_read_b128 v[136:139], v174 offset:8192
  ds_read_b128 v[140:143], v175 offset:8192
  s_waitcnt lgkmcnt(4)
  v_mfma_f32_16x16x32_bf16 v[196:199], v[144:147], v[224:227], 0
  v_mfma_f32_16x16x32_bf16 v[196:199], v[148:151], v[228:231], v[196:199]
  v_mfma_f32_16x16x32_bf16 v[196:199], v[152:155], v[232:235], v[196:199]
  v_mfma_f32_16x16x32_bf16 v[196:199], v[156:159], v[236:239], v[196:199]
  s_waitcnt vmcnt(16)
  ds_read_b128 v[144:147], v172 offset:12288
  ds_read_b128 v[148:151], v173 offset:12288
  ds_read_b128 v[152:155], v174 offset:12288
  ds_read_b128 v[156:159], v175 offset:12288
  s_waitcnt lgkmcnt(4)
  v_mfma_f32_16x16x32_bf16 v[200:203], v[128:131], v[224:227], 0
  v_mfma_f32_16x16x32_bf16 v[200:203], v[132:135], v[228:231], v[200:203]
  v_mfma_f32_16x16x32_bf16 v[200:203], v[136:139], v[232:235], v[200:203]
  v_mfma_f32_16x16x32_bf16 v[200:203], v[140:143], v[236:239], v[200:203]
  s_waitcnt lgkmcnt(0)
  v_mfma_f32_16x16x32_bf16 v[204:207], v[144:147], v[224:227], 0
  v_mfma_f32_16x16x32_bf16 v[204:207], v[148:151], v[228:231], v[204:207]
  v_mfma_f32_16x16x32_bf16 v[204:207], v[152:155], v[232:235], v[204:207]
  v_mfma_f32_16x16x32_bf16 v[204:207], v[156:159], v[236:239], v[204:207]
  v_mov_b32 v252, 17680
  ds_read_b32 v253, v252
  s_waitcnt lgkmcnt(0)
  v_readfirstlane_b32 s75, v253
  s_cmp_ge_u32 s75, 7
  s_cbranch_scc0 L_noahead
  v_mov_b32 v254, 1
  v_mov_b32 v255, 0
  s_mov_b64 exec, 1
  buffer_atomic_add v254, v255, s[40:43], s76 offen sc0 sc1
  s_mov_b64 exec, -1
L_noahead:
  s_nop 7
  v_max3_f32 v248, v192, v193, v194
  v_max3_f32 v248, v248, v195, v196
  v_max3_f32 v248, v248, v197, v198
  v_max3_f32 v248, v248, v199, v200
  v_max3_f32 v248, v248, v201, v202
  v_max3_f32 v248, v248, v203, v204
  v_max3_f32 v248, v248, v205, v206
  v_max_f32 v248, v248, v207
  v_mov_b32 v249, v248
  s_nop 1
  v_permlane16_swap_b32 v248, v249
  v_max_f32 v248, v248, v249
  v_mov_b32 v249, v248
  s_nop 1
  v_permlane32_swap_b32 v248, v249
  v_max_f32 v248, v248, v249
  v_cvt_pk_bf16_f32 v248, v248, v248
  v_lshlrev_b32 v248, 16, v248
  v_mul_f32 v248, s82, v248
  v_cvt_pk_bf16_f32 v248, v248, v248
  v_lshlrev_b32 v248, 16, v248
  v_mul_f32 v248, s31, v248
  v_cvt_pk_bf16_f32 v128, v192, v193
  v_cvt_pk_bf16_f32 v129, v194, v195
  v_cvt_pk_bf16_f32 v130, v196, v197
  v_cvt_pk_bf16_f32 v131, v198, v199
  v_cvt_pk_bf16_f32 v132, v200, v201
  v_cvt_pk_bf16_f32 v133, v202, v203
  v_cvt_pk_bf16_f32 v134, v204, v205
  v_cvt_pk_bf16_f32 v135, v206, v207
  v_lshlrev_b32 v192, 16, v128
  v_and_b32 v193, 0xffff0000, v128
  v_lshlrev_b32 v194, 16, v129
  v_and_b32 v195, 0xffff0000, v129
  v_lshlrev_b32 v196, 16, v130
  v_and_b32 v197, 0xffff0000, v130
  v_lshlrev_b32 v198, 16, v131
  v_and_b32 v199, 0xffff0000, v131
  v_lshlrev_b32 v200, 16, v132
  v_and_b32 v201, 0xffff0000, v132
  v_lshlrev_b32 v202, 16, v133
  v_and_b32 v203, 0xffff0000, v133
  v_lshlrev_b32 v204, 16, v134
  v_and_b32 v205, 0xffff0000, v134
  v_lshlrev_b32 v206, 16, v135
  v_and_b32 v207, 0xffff0000, v135
  v_mul_f32 v192, s82, v192
  v_mul_f32 v193, s82, v193
  v_mul_f32 v194, s82, v194
  v_mul_f32 v195, s82, v195
  v_mul_f32 v196, s82, v196
  v_mul_f32 v197, s82, v197
  v_mul_f32 v198, s82, v198
  v_mul_f32 v199, s82, v199
  v_mul_f32 v200, s82, v200
  v_mul_f32 v201, s82, v201
  v_mul_f32 v202, s82, v202
  v_mul_f32 v203, s82, v203
  v_mul_f32 v204, s82, v204
  v_mul_f32 v205, s82, v205
  v_mul_f32 v206, s82, v206
  v_mul_f32 v207, s82, v207
  v_cvt_pk_bf16_f32 v128, v192, v193
  v_cvt_pk_bf16_f32 v129, v194, v195
  v_cvt_pk_bf16_f32 v130, v196, v197
  v_cvt_pk_bf16_f32 v131, v198, v199
  v_cvt_pk_bf16_f32 v132, v200, v201
  v_cvt_pk_bf16_f32 v133, v202, v203
  v_cvt_pk_bf16_f32 v134, v204, v205
  v_cvt_pk_bf16_f32 v135, v206, v207
  v_lshlrev_b32 v192, 16, v128
  v_and_b32 v193, 0xffff0000, v128
  v_lshlrev_b32 v194, 16, v129
  v_and_b32 v195, 0xffff0000, v129
  v_lshlrev_b32 v196, 16, v130
  v_and_b32 v197, 0xffff0000, v130
  v_lshlrev_b32 v198, 16, v131
  v_and_b32 v199, 0xffff0000, v131
  v_lshlrev_b32 v200, 16, v132
  v_and_b32 v201, 0xffff0000, v132
  v_lshlrev_b32 v202, 16, v133
  v_and_b32 v203, 0xffff0000, v133
  v_lshlrev_b32 v204, 16, v134
  v_and_b32 v205, 0xffff0000, v134
  v_lshlrev_b32 v206, 16, v135
  v_and_b32 v207, 0xffff0000, v135
  v_fma_f32 v192, v192, s31, -v248
  v_fma_f32 v193, v193, s31, -v248
  v_fma_f32 v194, v194, s31, -v248
  v_fma_f32 v195, v195, s31, -v248
  v_fma_f32 v196, v196, s31, -v248
  v_fma_f32 v197, v197, s31, -v248
  v_fma_f32 v198, v198, s31, -v248
  v_fma_f32 v199, v199, s31, -v248
  v_fma_f32 v200, v200, s31, -v248
  v_fma_f32 v201, v201, s31, -v248
  v_fma_f32 v202, v202, s31, -v248
  v_fma_f32 v203, v203, s31, -v248
  v_fma_f32 v204, v204, s31, -v248
  v_fma_f32 v205, v205, s31, -v248
  v_fma_f32 v206, v206, s31, -v248
  v_fma_f32 v207, v207, s31, -v248
  v_exp_f32 v192, v192
  v_exp_f32 v193, v193
  v_exp_f32 v194, v194
  v_exp_f32 v195, v195
  v_exp_f32 v196, v196
  v_exp_f32 v197, v197
  v_exp_f32 v198, v198
  v_exp_f32 v199, v199
  v_exp_f32 v200, v200
  v_exp_f32 v201, v201
  v_exp_f32 v202, v202
  v_exp_f32 v203, v203
  v_exp_f32 v204, v204
  v_exp_f32 v205, v205
  v_exp_f32 v206, v206
  v_exp_f32 v207, v207
  s_nop 0
  v_add_f32 v250, v192, v193
  v_add_f32 v250, v250, v194
  v_add_f32 v250, v250, v195
  v_add_f32 v250, v250, v196
  v_add_f32 v250, v250, v197
  v_add_f32 v250, v250, v198
  v_add_f32 v250, v250, v199
  v_add_f32 v250, v250, v200
  v_add_f32 v250, v250, v201
  v_add_f32 v250, v250, v202
  v_add_f32 v250, v250, v203
  v_add_f32 v250, v250, v204
  v_add_f32 v250, v250, v205
  v_add_f32 v250, v250, v206
  v_add_f32 v250, v250, v207
  v_cvt_pk_bf16_f32 v224, v192, v193
  v_cvt_pk_bf16_f32 v225, v194, v195
  v_cvt_pk_bf16_f32 v226, v196, v197
  v_cvt_pk_bf16_f32 v227, v198, v199
  v_cvt_pk_bf16_f32 v228, v200, v201
  v_cvt_pk_bf16_f32 v229, v202, v203
  v_cvt_pk_bf16_f32 v230, v204, v205
  v_cvt_pk_bf16_f32 v231, v206, v207
  v_mov_b32 v249, v250
  s_nop 1
  v_permlane16_swap_b32 v250, v249
  v_add_f32 v250, v250, v249
  v_mov_b32 v249, v250
  s_nop 1
  v_permlane32_swap_b32 v250, v249
  v_add_f32 v250, v250, v249
  s_waitcnt vmcnt(8)
  v_perm_b32 v160, v4, v0, s80
  v_perm_b32 v161, v12, v8, s80
  v_perm_b32 v162, v20, v16, s80
  v_perm_b32 v163, v28, v24, s80
  v_perm_b32 v164, v4, v0, s81
  v_perm_b32 v165, v12, v8, s81
  v_perm_b32 v166, v20, v16, s81
  v_perm_b32 v167, v28, v24, s81
  v_mfma_f32_16x16x32_bf16 v[192:195], v[224:227], v[160:163], 0
  v_perm_b32 v160, v5, v1, s80
  v_perm_b32 v161, v13, v9, s80
  v_perm_b32 v162, v21, v17, s80
  v_perm_b32 v163, v29, v25, s80
  v_mfma_f32_16x16x32_bf16 v[196:199], v[224:227], v[164:167], 0
  v_perm_b32 v164, v5, v1, s81
  v_perm_b32 v165, v13, v9, s81
  v_perm_b32 v166, v21, v17, s81
  v_perm_b32 v167, v29, v25, s81
  v_mfma_f32_16x16x32_bf16 v[200:203], v[224:227], v[160:163], 0
  v_perm_b32 v160, v6, v2, s80
  v_perm_b32 v161, v14, v10, s80
  v_perm_b32 v162, v22, v18, s80
  v_perm_b32 v163, v30, v26, s80
  v_mfma_f32_16x16x32_bf16 v[204:207], v[224:227], v[164:167], 0
  v_perm_b32 v164, v6, v2, s81
  v_perm_b32 v165, v14, v10, s81
  v_perm_b32 v166, v22, v18, s81
  v_perm_b32 v167, v30, v26, s81
  v_mfma_f32_16x16x32_bf16 v[208:211], v[224:227], v[160:163], 0
  v_perm_b32 v160, v7, v3, s80
  v_perm_b32 v161, v15, v11, s80
  v_perm_b32 v162, v23, v19, s80
  v_perm_b32 v163, v31, v27, s80
  v_mfma_f32_16x16x32_bf16 v[212:215], v[224:227], v[164:167], 0
  v_perm_b32 v164, v7, v3, s81
  v_perm_b32 v165, v15, v11, s81
  v_perm_b32 v166, v23, v19, s81
  v_perm_b32 v167, v31, v27, s81
  v_mfma_f32_16x16x32_bf16 v[216:219], v[224:227], v[160:163], 0
  s_nop 1
  v_mfma_f32_16x16x32_bf16 v[220:223], v[224:227], v[164:167], 0
  s_waitcnt vmcnt(0)
  v_perm_b32 v160, v36, v32, s80
  v_perm_b32 v161, v44, v40, s80
  v_perm_b32 v162, v52, v48, s80
  v_perm_b32 v163, v60, v56, s80
  v_perm_b32 v164, v36, v32, s81
  v_perm_b32 v165, v44, v40, s81
  v_perm_b32 v166, v52, v48, s81
  v_perm_b32 v167, v60, v56, s81
  v_mfma_f32_16x16x32_bf16 v[192:195], v[228:231], v[160:163], v[192:195]
  v_perm_b32 v160, v37, v33, s80
  v_perm_b32 v161, v45, v41, s80
  v_perm_b32 v162, v53, v49, s80
  v_perm_b32 v163, v61, v57, s80
  v_mfma_f32_16x16x32_bf16 v[196:199], v[228:231], v[164:167], v[196:199]
  v_perm_b32 v164, v37, v33, s81
  v_perm_b32 v165, v45, v41, s81
  v_perm_b32 v166, v53, v49, s81
  v_perm_b32 v167, v61, v57, s81
  v_mfma_f32_16x16x32_bf16 v[200:203], v[228:231], v[160:163], v[200:203]
  v_perm_b32 v160, v38, v34, s80
  v_perm_b32 v161, v46, v42, s80
  v_perm_b32 v162, v54, v50, s80
  v_perm_b32 v163, v62, v58, s80
  v_mfma_f32_16x16x32_bf16 v[204:207], v[228:231], v[164:167], v[204:207]
  v_perm_b32 v164, v38, v34, s81
  v_perm_b32 v165, v46, v42, s81
  v_perm_b32 v166, v54, v50, s81
  v_perm_b32 v167, v62, v58, s81
  v_mfma_f32_16x16x32_bf16 v[208:211], v[228:231], v[160:163], v[208:211]
  v_perm_b32 v160, v39, v35, s80
  v_perm_b32 v161, v47, v43, s80
  v_perm_b32 v162, v55, v51, s80
  v_perm_b32 v163, v63, v59, s80
  v_mfma_f32_16x16x32_bf16 v[212:215], v[228:231], v[164:167], v[212:215]
  v_perm_b32 v164, v39, v35, s81
  v_perm_b32 v165, v47, v43, s81
  v_perm_b32 v166, v55, v51, s81
  v_perm_b32 v167, v63, v59, s81
  v_mfma_f32_16x16x32_bf16 v[216:219], v[228:231], v[160:163], v[216:219]
  s_nop 1
  v_mfma_f32_16x16x32_bf16 v[220:223], v[228:231], v[164:167], v[220:223]
  s_lshl_b32 s67, s60, 11
  v_lshlrev_b32 v251, 5, v243
  v_add_u32 v251, s67, v251
  s_nop 5
  v_mov_b32 v0, v192
  v_mov_b32 v1, v196
  v_mov_b32 v2, v200
  v_mov_b32 v3, v204
  v_mov_b32 v4, v208
  v_mov_b32 v5, v212
  v_mov_b32 v6, v216
  v_mov_b32 v7, v220
  v_mov_b32 v8, v193
  v_mov_b32 v9, v197
  v_mov_b32 v10, v201
  v_mov_b32 v11, v205
  v_mov_b32 v12, v209
  v_mov_b32 v13, v213
  v_mov_b32 v14, v217
  v_mov_b32 v15, v221
  v_mov_b32 v16, v194
  v_mov_b32 v17, v198
  v_mov_b32 v18, v202
  v_mov_b32 v19, v206
  v_mov_b32 v20, v210
  v_mov_b32 v21, v214
  v_mov_b32 v22, v218
  v_mov_b32 v23, v222
  v_mov_b32 v24, v195
  v_mov_b32 v25, v199
  v_mov_b32 v26, v203
  v_mov_b32 v27, v207
  v_mov_b32 v28, v211
  v_mov_b32 v29, v215
  v_mov_b32 v30, v219
  v_mov_b32 v31, v223
  s_waitcnt vmcnt(0)
  s_mov_b32 s66, s75
  s_lshl_b32 s67, s60, 5
  v_mov_b32 v32, s67
  ds_read_b64 v[34:35], v32 offset:17408
  ds_read_b64 v[36:37], v32 offset:17416
  ds_read_b64 v[38:39], v32 offset:17424
  ds_read_b64 v[40:41], v32 offset:17432
  ds_read_b128 v[64:67], v251 offset:1024
  ds_read_b128 v[68:71], v251 offset:1040
  ds_read_b128 v[72:75], v251 offset:1536
  ds_read_b128 v[76:79], v251 offset:1552
  ds_read_b128 v[80:83], v251 offset:2048
  ds_read_b128 v[84:87], v251 offset:2064
  ds_read_b128 v[88:91], v251 offset:2560
  ds_read_b128 v[92:95], v251 offset:2576
  v_readlane_b32 s68, v248, 0
  v_readlane_b32 s72, v250, 0
  v_readlane_b32 s69, v248, 1
  v_readlane_b32 s73, v250, 1
  v_readlane_b32 s70, v248, 2
  v_readlane_b32 s74, v250, 2
  v_readlane_b32 s71, v248, 3
  v_readlane_b32 s75, v250, 3
  s_waitcnt lgkmcnt(0)
  v_max_f32 v44, s68, v34
  v_sub_f32 v45, v34, v44
  v_sub_f32 v46, s68, v44
  v_exp_f32 v45, v45
  v_exp_f32 v46, v46
  s_nop 0
  v_mul_f32 v35, v35, v45
  v_fma_f32 v35, v46, s72, v35
  v_mov_b32 v34, v44
  v_mul_f32 v0, v0, v46
  v_fmac_f32 v0, v64, v45
  v_mul_f32 v1, v1, v46
  v_fmac_f32 v1, v65, v45
  v_mul_f32 v2, v2, v46
  v_fmac_f32 v2, v66, v45
  v_mul_f32 v3, v3, v46
  v_fmac_f32 v3, v67, v45
  v_mul_f32 v4, v4, v46
  v_fmac_f32 v4, v68, v45
  v_mul_f32 v5, v5, v46
  v_fmac_f32 v5, v69, v45
  v_mul_f32 v6, v6, v46
  v_fmac_f32 v6, v70, v45
  v_mul_f32 v7, v7, v46
  v_fmac_f32 v7, v71, v45
  v_max_f32 v44, s69, v36
  v_sub_f32 v45, v36, v44
  v_sub_f32 v46, s69, v44
  v_exp_f32 v45, v45
  v_exp_f32 v46, v46
  s_nop 0
  v_mul_f32 v37, v37, v45
  v_fma_f32 v37, v46, s73, v37
  v_mov_b32 v36, v44
  v_mul_f32 v8, v8, v46
  v_fmac_f32 v8, v72, v45
  v_mul_f32 v9, v9, v46
  v_fmac_f32 v9, v73, v45
  v_mul_f32 v10, v10, v46
  v_fmac_f32 v10, v74, v45
  v_mul_f32 v11, v11, v46
  v_fmac_f32 v11, v75, v45
  v_mul_f32 v12, v12, v46
  v_fmac_f32 v12, v76, v45
  v_mul_f32 v13, v13, v46
  v_fmac_f32 v13, v77, v45
  v_mul_f32 v14, v14, v46
  v_fmac_f32 v14, v78, v45
  v_mul_f32 v15, v15, v46
  v_fmac_f32 v15, v79, v45
  v_max_f32 v44, s70, v38
  v_sub_f32 v45, v38, v44
  v_sub_f32 v46, s70, v44
  v_exp_f32 v45, v45
  v_exp_f32 v46, v46
  s_nop 0
  v_mul_f32 v39, v39, v45
  v_fma_f32 v39, v46, s74, v39
  v_mov_b32 v38, v44
  v_mul_f32 v16, v16, v46
  v_fmac_f32 v16, v80, v45
  v_mul_f32 v17, v17, v46
  v_fmac_f32 v17, v81, v45
  v_mul_f32 v18, v18, v46
  v_fmac_f32 v18, v82, v45
  v_mul_f32 v19, v19, v46
  v_fmac_f32 v19, v83, v45
  v_mul_f32 v20, v20, v46
  v_fmac_f32 v20, v84, v45
  v_mul_f32 v21, v21, v46
  v_fmac_f32 v21, v85, v45
  v_mul_f32 v22, v22, v46
  v_fmac_f32 v22, v86, v45
  v_mul_f32 v23, v23, v46
  v_fmac_f32 v23, v87, v45
  v_max_f32 v44, s71, v40
  v_sub_f32 v45, v40, v44
  v_sub_f32 v46, s71, v44
  v_exp_f32 v45, v45
  v_exp_f32 v46, v46
  s_nop 0
  v_mul_f32 v41, v41, v45
  v_fma_f32 v41, v46, s75, v41
  v_mov_b32 v40, v44
  v_mul_f32 v24, v24, v46
  v_fmac_f32 v24, v88, v45
  v_mul_f32 v25, v25, v46
  v_fmac_f32 v25, v89, v45
  v_mul_f32 v26, v26, v46
  v_fmac_f32 v26, v90, v45
  v_mul_f32 v27, v27, v46
  v_fmac_f32 v27, v91, v45
  v_mul_f32 v28, v28, v46
  v_fmac_f32 v28, v92, v45
  v_mul_f32 v29, v29, v46
  v_fmac_f32 v29, v93, v45
  v_mul_f32 v30, v30, v46
  v_fmac_f32 v30, v94, v45
  v_mul_f32 v31, v31, v46
  v_fmac_f32 v31, v95, v45
  v_readfirstlane_b32 s68, v34
  v_readfirstlane_b32 s72, v35
  v_readfirstlane_b32 s69, v36
  v_readfirstlane_b32 s73, v37
  v_readfirstlane_b32 s70, v38
  v_readfirstlane_b32 s74, v39
  v_readfirstlane_b32 s71, v40
  v_readfirstlane_b32 s75, v41
  s_nop 3
  v_writelane_b32 v248, s68, 0
  v_writelane_b32 v250, s72, 0
  v_writelane_b32 v248, s69, 1
  v_writelane_b32 v250, s73, 1
  v_writelane_b32 v248, s70, 2
  v_writelane_b32 v250, s74, 2
  v_writelane_b32 v248, s71, 3
  v_writelane_b32 v250, s75, 3
  v_cmp_gt_u32 vcc, 16, v241
  s_nop 1
  s_and_saveexec_b64 s[70:71], vcc
  ds_write_b128 v251, v[0:3] offset:1024
  ds_write_b128 v251, v[4:7] offset:1040
  ds_write_b128 v251, v[8:11] offset:1536
  ds_write_b128 v251, v[12:15] offset:1552
  ds_write_b128 v251, v[16:19] offset:2048
  ds_write_b128 v251, v[20:23] offset:2064
  ds_write_b128 v251, v[24:27] offset:2560
  ds_write_b128 v251, v[28:31] offset:2576
  s_mov_b64 exec, s[70:71]
  s_lshl_b32 s67, s60, 5
  v_lshlrev_b32 v251, 3, v241
  v_add_u32 v251, s67, v251
  v_mov_b32 v252, v248
  v_mov_b32 v253, v250
  v_cmp_gt_u32 vcc, 4, v241
  s_nop 1
  s_and_saveexec_b64 s[70:71], vcc
  ds_write_b64 v251, v[252:253] offset:17408
  s_mov_b64 exec, s[70:71]
  s_waitcnt lgkmcnt(0)
  s_cmp_ge_u32 s66, 7
  s_cbranch_scc1 L_claimed
  s_branch L_pool
L_stage1:
  s_setprio 3
  s_cmp_ge_u32 s62, 4
  s_cbranch_scc1 L_s1_nocnt
  s_lshl_b32 s68, s62, 3
  s_add_u32 s68, s68, s61
  s_lshl_b32 s68, s68, 7
  s_add_u32 s68, s68, 0x310000
  v_mov_b32 v172, 0
  s_mov_b64 exec, 1
  buffer_store_dword v172, v172, s[40:43], s68 offen sc1
  s_mov_b64 exec, -1
L_s1_nocnt:
  s_cmp_ge_u32 s62, 30
  s_cbranch_scc1 L_s1_clr
  s_cmp_ge_u32 s62, 16
  s_cbranch_scc1 L_s1_ffn
  s_mov_b32 s48, s10
  s_and_b32 s49, s11, 0xffff
  s_mov_b32 s50, 0x400000
  s_mov_b32 s51, 0x00020000
  s_movk_i32 s72, 8192
  s_lshl_b32 s68, s61, 2
  s_lshr_b32 s69, s62, 2
  s_add_u32 s68, s68, s69
  s_and_b32 s73, s62, 3
  s_lshl_b32 s74, s68, 8
  s_lshl_b32 s75, s68, 9
  s_branch L_s1_go
L_s1_ffn:
  s_mul_i32 s68, s61, 14
  s_add_u32 s68, s68, s62
  s_sub_u32 s68, s68, 16
  s_and_b32 s73, s68, 3
  s_lshr_b32 s68, s68, 2
  s_movk_i32 s72, 3584
  s_lshl_b32 s75, s68, 9
  s_add_u32 s75, s75, 16384
  s_cmp_ge_u32 s68, 14
  s_cselect_b32 s48, s18, s16
  s_cselect_b32 s49, s19, s17
  s_cselect_b32 s69, 14, 0
  s_and_b32 s49, s49, 0xffff
  s_mov_b32 s50, 0x1c0000
  s_mov_b32 s51, 0x00020000
  s_sub_u32 s68, s68, s69
  s_lshl_b32 s74, s68, 8
L_s1_go:
  s_lshl_b32 s68, s73, 7
  v_lshlrev_b32 v164, 3, v242
  v_add_u32 v164, s68, v164
  v_and_b32 v165, 3, v243
  v_lshlrev_b32 v165, 10, v165
  v_lshl_add_u32 v165, v164, 1, v165
  v_mul_lo_u32 v166, v164, s72
  v_lshl_add_u32 v166, v243, 4, v166
  v_add_u32 v166, s74, v166
  s_mov_b32 s69, 0
  s_mul_i32 s67, s72, 24
  buffer_load_dwordx4 v[128:131], v165, s[52:55], 0 offen offset:0
  buffer_load_dwordx4 v[0:3], v166, s[48:51], s69 offen nt
  s_add_u32 s69, s69, s72
  buffer_load_dwordx4 v[4:7], v166, s[48:51], s69 offen nt
  s_add_u32 s69, s69, s72
  buffer_load_dwordx4 v[8:11], v166, s[48:51], s69 offen nt
  s_add_u32 s69, s69, s72
  buffer_load_dwordx4 v[12:15], v166, s[48:51], s69 offen nt
  s_add_u32 s69, s69, s72
  buffer_load_dwordx4 v[16:19], v166, s[48:51], s69 offen nt
  s_add_u32 s69, s69, s72
  buffer_load_dwordx4 v[20:23], v166, s[48:51], s69 offen nt
  s_add_u32 s69, s69, s72
  buffer_load_dwordx4 v[24:27], v166, s[48:51], s69 offen nt
  s_add_u32 s69, s69, s72
  buffer_load_dwordx4 v[28:31], v166, s[48:51], s69 offen nt
  s_add_u32 s69, s69, s72
  s_add_u32 s69, s69, s67
  buffer_load_dwordx4 v[132:135], v165, s[52:55], 0 offen offset:64
  buffer_load_dwordx4 v[32:35], v166, s[48:51], s69 offen nt
  s_add_u32 s69, s69, s72
  buffer_load_dwordx4 v[36:39], v166, s[48:51], s69 offen nt
  s_add_u32 s69, s69, s72
  buffer_load_dwordx4 v[40:43], v166, s[48:51], s69 offen nt
  s_add_u32 s69, s69, s72
  buffer_load_dwordx4 v[44:47], v166, s[48:51], s69 offen nt
  s_add_u32 s69, s69, s72
  buffer_load_dwordx4 v[48:51], v166, s[48:51], s69 offen nt
  s_add_u32 s69, s69, s72
  buffer_load_dwordx4 v[52:55], v166, s[48:51], s69 offen nt
  s_add_u32 s69, s69, s72
  buffer_load_dwordx4 v[56:59], v166, s[48:51], s69 offen nt
  s_add_u32 s69, s69, s72
  buffer_load_dwordx4 v[60:63], v166, s[48:51], s69 offen nt
  s_add_u32 s69, s69, s72
  s_add_u32 s69, s69, s67
  buffer_load_dwordx4 v[136:139], v165, s[52:55], 0 offen offset:128
  buffer_load_dwordx4 v[64:67], v166, s[48:51], s69 offen nt
  s_add_u32 s69, s69, s72
  buffer_load_dwordx4 v[68:71], v166, s[48:51], s69 offen nt
  s_add_u32 s69, s69, s72
  buffer_load_dwordx4 v[72:75], v166, s[48:51], s69 offen nt
  s_add_u32 s69, s69, s72
  buffer_load_dwordx4 v[76:79], v166, s[48:51], s69 offen nt
  s_add_u32 s69, s69, s72
  buffer_load_dwordx4 v[80:83], v166, s[48:51], s69 offen nt
  s_add_u32 s69, s69, s72
  buffer_load_dwordx4 v[84:87], v166, s[48:51], s69 offen nt
  s_add_u32 s69, s69, s72
  buffer_load_dwordx4 v[88:91], v166, s[48:51], s69 offen nt
  s_add_u32 s69, s69, s72
  buffer_load_dwordx4 v[92:95], v166, s[48:51], s69 offen nt
  s_add_u32 s69, s69, s72
  s_add_u32 s69, s69, s67
  buffer_load_dwordx4 v[140:143], v165, s[52:55], 0 offen offset:192
  buffer_load_dwordx4 v[96:99], v166, s[48:51], s69 offen nt
  s_add_u32 s69, s69, s72
  buffer_load_dwordx4 v[100:103], v166, s[48:51], s69 offen nt
  s_add_u32 s69, s69, s72
  buffer_load_dwordx4 v[104:107], v166, s[48:51], s69 offen nt
  s_add_u32 s69, s69, s72
  buffer_load_dwordx4 v[108:111], v166, s[48:51], s69 offen nt
  s_add_u32 s69, s69, s72
  buffer_load_dwordx4 v[112:115], v166, s[48:51], s69 offen nt
  s_add_u32 s69, s69, s72
  buffer_load_dwordx4 v[116:119], v166, s[48:51], s69 offen nt
  s_add_u32 s69, s69, s72
  buffer_load_dwordx4 v[120:123], v166, s[48:51], s69 offen nt
  s_add_u32 s69, s69, s72
  buffer_load_dwordx4 v[124:127], v166, s[48:51], s69 offen nt
  s_add_u32 s69, s69, s72
L_s1_clr:
  v_mov_b32 v170, 17664
  v_mov_b32 v171, 1
  ds_write_b32 v170, v171
  v_mov_b32 v172, 0
  s_mov_b64 exec, 1
  buffer_load_dwordx2 v[168:169], v172, s[44:47], 0 offen sc1
  s_mov_b64 exec, -1
  v_mov_b32 v160, -1
  v_mov_b32 v161, -1
  v_mov_b32 v162, -1
  v_mov_b32 v163, -1
  s_lshl_b32 s67, s65, 5
  s_add_u32 s67, s67, s64
  s_mul_i32 s68, s67, 640
  s_add_u32 s68, s68, 0x100000
  v_mul_u32_u24 v172, 5120, v242
  v_lshl_add_u32 v172, v243, 4, v172
  buffer_store_dwordx4 v[160:163], v172, s[40:43], s68 offen sc1
  buffer_store_dwordx4 v[160:163], v172, s[40:43], s68 offen offset:256 sc1
  s_mov_b32 exec_lo, 0x00010001
  s_mov_b32 exec_hi, 0x00010001
  buffer_store_dwordx2 v[160:161], v172, s[40:43], s68 offen offset:512 sc1
  s_mov_b64 exec, -1
  s_and_b32 s69, s62, 3
  s_mul_i32 s69, s69, 92
  s_lshl_b32 s68, s61, 3
  s_add_u32 s69, s69, s68
  s_lshr_b32 s68, s62, 2
  s_add_u32 s69, s69, s68
  s_lshl_b32 s69, s69, 11
  s_add_u32 s69, s69, 0x200000
  v_lshlrev_b32 v172, 4, v241
  buffer_store_dwordx4 v[160:163], v172, s[40:43], s69 offen sc1
  buffer_store_dwordx4 v[160:163], v172, s[40:43], s69 offen offset:1024 sc1
  s_cmp_ge_u32 s2, 112
  s_cbranch_scc1 L_s1_noffnclr
  s_and_b32 s69, s2, 3
  s_mul_i32 s69, s69, 92
  s_lshr_b32 s68, s2, 2
  s_add_u32 s69, s69, s68
  s_add_u32 s69, s69, 64
  s_lshl_b32 s69, s69, 11
  s_add_u32 s69, s69, 0x200000
  buffer_store_dwordx4 v[160:163], v172, s[40:43], s69 offen sc1
  buffer_store_dwordx4 v[160:163], v172, s[40:43], s69 offen offset:1024 sc1
L_s1_noffnclr:
  s_cmp_ge_u32 s62, 30
  s_cbranch_scc1 L_s1_gate
  s_waitcnt vmcnt(33)
  v_perm_b32 v144, v4, v0, s80
  v_perm_b32 v145, v12, v8, s80
  v_perm_b32 v146, v20, v16, s80
  v_perm_b32 v147, v28, v24, s80
  v_perm_b32 v148, v4, v0, s81
  v_perm_b32 v149, v12, v8, s81
  v_perm_b32 v150, v20, v16, s81
  v_perm_b32 v151, v28, v24, s81
  v_mfma_f32_16x16x32_bf16 v[192:195], v[128:131], v[144:147], 0
  v_perm_b32 v144, v5, v1, s80
  v_perm_b32 v145, v13, v9, s80
  v_perm_b32 v146, v21, v17, s80
  v_perm_b32 v147, v29, v25, s80
  v_mfma_f32_16x16x32_bf16 v[196:199], v[128:131], v[148:151], 0
  v_perm_b32 v148, v5, v1, s81
  v_perm_b32 v149, v13, v9, s81
  v_perm_b32 v150, v21, v17, s81
  v_perm_b32 v151, v29, v25, s81
  v_mfma_f32_16x16x32_bf16 v[200:203], v[128:131], v[144:147], 0
  v_perm_b32 v144, v6, v2, s80
  v_perm_b32 v145, v14, v10, s80
  v_perm_b32 v146, v22, v18, s80
  v_perm_b32 v147, v30, v26, s80
  v_mfma_f32_16x16x32_bf16 v[204:207], v[128:131], v[148:151], 0
  v_perm_b32 v148, v6, v2, s81
  v_perm_b32 v149, v14, v10, s81
  v_perm_b32 v150, v22, v18, s81
  v_perm_b32 v151, v30, v26, s81
  v_mfma_f32_16x16x32_bf16 v[208:211], v[128:131], v[144:147], 0
  v_perm_b32 v144, v7, v3, s80
  v_perm_b32 v145, v15, v11, s80
  v_perm_b32 v146, v23, v19, s80
  v_perm_b32 v147, v31, v27, s80
  v_mfma_f32_16x16x32_bf16 v[212:215], v[128:131], v[148:151], 0
  v_perm_b32 v148, v7, v3, s81
  v_perm_b32 v149, v15, v11, s81
  v_perm_b32 v150, v23, v19, s81
  v_perm_b32 v151, v31, v27, s81
  v_mfma_f32_16x16x32_bf16 v[216:219], v[128:131], v[144:147], 0
  s_nop 1
  v_mfma_f32_16x16x32_bf16 v[220:223], v[128:131], v[148:151], 0
  s_waitcnt vmcnt(24)
  v_perm_b32 v144, v36, v32, s80
  v_perm_b32 v145, v44, v40, s80
  v_perm_b32 v146, v52, v48, s80
  v_perm_b32 v147, v60, v56, s80
  v_perm_b32 v148, v36, v32, s81
  v_perm_b32 v149, v44, v40, s81
  v_perm_b32 v150, v52, v48, s81
  v_perm_b32 v151, v60, v56, s81
  v_mfma_f32_16x16x32_bf16 v[192:195], v[132:135], v[144:147], v[192:195]
  v_perm_b32 v144, v37, v33, s80
  v_perm_b32 v145, v45, v41, s80
  v_perm_b32 v146, v53, v49, s80
  v_perm_b32 v147, v61, v57, s80
  v_mfma_f32_16x16x32_bf16 v[196:199], v[132:135], v[148:151], v[196:199]
  v_perm_b32 v148, v37, v33, s81
  v_perm_b32 v149, v45, v41, s81
  v_perm_b32 v150, v53, v49, s81
  v_perm_b32 v151, v61, v57, s81
  v_mfma_f32_16x16x32_bf16 v[200:203], v[132:135], v[144:147], v[200:203]
  v_perm_b32 v144, v38, v34, s80
  v_perm_b32 v145, v46, v42, s80
  v_perm_b32 v146, v54, v50, s80
  v_perm_b32 v147, v62, v58, s80
  v_mfma_f32_16x16x32_bf16 v[204:207], v[132:135], v[148:151], v[204:207]
  v_perm_b32 v148, v38, v34, s81
  v_perm_b32 v149, v46, v42, s81
  v_perm_b32 v150, v54, v50, s81
  v_perm_b32 v151, v62, v58, s81
  v_mfma_f32_16x16x32_bf16 v[208:211], v[132:135], v[144:147], v[208:211]
  v_perm_b32 v144, v39, v35, s80
  v_perm_b32 v145, v47, v43, s80
  v_perm_b32 v146, v55, v51, s80
  v_perm_b32 v147, v63, v59, s80
  v_mfma_f32_16x16x32_bf16 v[212:215], v[132:135], v[148:151], v[212:215]
  v_perm_b32 v148, v39, v35, s81
  v_perm_b32 v149, v47, v43, s81
  v_perm_b32 v150, v55, v51, s81
  v_perm_b32 v151, v63, v59, s81
  v_mfma_f32_16x16x32_bf16 v[216:219], v[132:135], v[144:147], v[216:219]
  s_nop 1
  v_mfma_f32_16x16x32_bf16 v[220:223], v[132:135], v[148:151], v[220:223]
  s_waitcnt vmcnt(15)
  v_perm_b32 v144, v68, v64, s80
  v_perm_b32 v145, v76, v72, s80
  v_perm_b32 v146, v84, v80, s80
  v_perm_b32 v147, v92, v88, s80
  v_perm_b32 v148, v68, v64, s81
  v_perm_b32 v149, v76, v72, s81
  v_perm_b32 v150, v84, v80, s81
  v_perm_b32 v151, v92, v88, s81
  v_mfma_f32_16x16x32_bf16 v[192:195], v[136:139], v[144:147], v[192:195]
  v_perm_b32 v144, v69, v65, s80
  v_perm_b32 v145, v77, v73, s80
  v_perm_b32 v146, v85, v81, s80
  v_perm_b32 v147, v93, v89, s80
  v_mfma_f32_16x16x32_bf16 v[196:199], v[136:139], v[148:151], v[196:199]
  v_perm_b32 v148, v69, v65, s81
  v_perm_b32 v149, v77, v73, s81
  v_perm_b32 v150, v85, v81, s81
  v_perm_b32 v151, v93, v89, s81
  v_mfma_f32_16x16x32_bf16 v[200:203], v[136:139], v[144:147], v[200:203]
  v_perm_b32 v144, v70, v66, s80
  v_perm_b32 v145, v78, v74, s80
  v_perm_b32 v146, v86, v82, s80
  v_perm_b32 v147, v94, v90, s80
  v_mfma_f32_16x16x32_bf16 v[204:207], v[136:139], v[148:151], v[204:207]
  v_perm_b32 v148, v70, v66, s81
  v_perm_b32 v149, v78, v74, s81
  v_perm_b32 v150, v86, v82, s81
  v_perm_b32 v151, v94, v90, s81
  v_mfma_f32_16x16x32_bf16 v[208:211], v[136:139], v[144:147], v[208:211]
  v_perm_b32 v144, v71, v67, s80
  v_perm_b32 v145, v79, v75, s80
  v_perm_b32 v146, v87, v83, s80
  v_perm_b32 v147, v95, v91, s80
  v_mfma_f32_16x16x32_bf16 v[212:215], v[136:139], v[148:151], v[212:215]
  v_perm_b32 v148, v71, v67, s81
  v_perm_b32 v149, v79, v75, s81
  v_perm_b32 v150, v87, v83, s81
  v_perm_b32 v151, v95, v91, s81
  v_mfma_f32_16x16x32_bf16 v[216:219], v[136:139], v[144:147], v[216:219]
  s_nop 1
  v_mfma_f32_16x16x32_bf16 v[220:223], v[136:139], v[148:151], v[220:223]
  s_waitcnt vmcnt(6)
  v_perm_b32 v144, v100, v96, s80
  v_perm_b32 v145, v108, v104, s80
  v_perm_b32 v146, v116, v112, s80
  v_perm_b32 v147, v124, v120, s80
  v_perm_b32 v148, v100, v96, s81
  v_perm_b32 v149, v108, v104, s81
  v_perm_b32 v150, v116, v112, s81
  v_perm_b32 v151, v124, v120, s81
  v_mfma_f32_16x16x32_bf16 v[192:195], v[140:143], v[144:147], v[192:195]
  v_perm_b32 v144, v101, v97, s80
  v_perm_b32 v145, v109, v105, s80
  v_perm_b32 v146, v117, v113, s80
  v_perm_b32 v147, v125, v121, s80
  v_mfma_f32_16x16x32_bf16 v[196:199], v[140:143], v[148:151], v[196:199]
  v_perm_b32 v148, v101, v97, s81
  v_perm_b32 v149, v109, v105, s81
  v_perm_b32 v150, v117, v113, s81
  v_perm_b32 v151, v125, v121, s81
  v_mfma_f32_16x16x32_bf16 v[200:203], v[140:143], v[144:147], v[200:203]
  v_perm_b32 v144, v102, v98, s80
  v_perm_b32 v145, v110, v106, s80
  v_perm_b32 v146, v118, v114, s80
  v_perm_b32 v147, v126, v122, s80
  v_mfma_f32_16x16x32_bf16 v[204:207], v[140:143], v[148:151], v[204:207]
  v_perm_b32 v148, v102, v98, s81
  v_perm_b32 v149, v110, v106, s81
  v_perm_b32 v150, v118, v114, s81
  v_perm_b32 v151, v126, v122, s81
  v_mfma_f32_16x16x32_bf16 v[208:211], v[140:143], v[144:147], v[208:211]
  v_perm_b32 v144, v103, v99, s80
  v_perm_b32 v145, v111, v107, s80
  v_perm_b32 v146, v119, v115, s80
  v_perm_b32 v147, v127, v123, s80
  v_mfma_f32_16x16x32_bf16 v[212:215], v[140:143], v[148:151], v[212:215]
  v_perm_b32 v148, v103, v99, s81
  v_perm_b32 v149, v111, v107, s81
  v_perm_b32 v150, v119, v115, s81
  v_perm_b32 v151, v127, v123, s81
  v_mfma_f32_16x16x32_bf16 v[216:219], v[140:143], v[144:147], v[216:219]
  s_nop 1
  v_mfma_f32_16x16x32_bf16 v[220:223], v[140:143], v[148:151], v[220:223]
  s_waitcnt vmcnt(5)
  v_mov_b32 v164, 0
  s_mov_b64 exec, 1
L_pollNa:
  v_readfirstlane_b32 s78, v168
  v_readfirstlane_b32 s79, v169
  s_and_b32 s68, s78, 1
  s_lshr_b32 s69, s79, 31
  s_and_b32 s68, s68, s69
  s_cmp_eq_u32 s68, 1
  s_cbranch_scc1 L_pollNa_done
  s_add_u32 s83, s83, 1
  s_cmp_gt_u32 s83, 0x40000
  s_cbranch_scc1 L_pollNa_done
  buffer_load_dwordx2 v[168:169], v164, s[44:47], 0 offen sc1
  s_waitcnt vmcnt(0)
  s_branch L_pollNa
L_pollNa_done:
  s_mov_b64 exec, -1
  s_mul_i32 s68, s78, 0x9e3779b1
  s_mul_i32 s69, s78, 0x85ebca6b
  s_xor_b32 s69, s69, s79
  s_lshr_b32 s67, s68, 20
  v_mov_b32 v176, s67
  s_bfe_u32 s67, s68, 0xc0008
  v_mov_b32 v177, s67
  s_lshr_b32 s67, s69, 20
  v_mov_b32 v178, s67
  s_bfe_u32 s67, s69, 0xc0008
  v_mov_b32 v179, s67
  s_mov_b32 s67, 0xfffff000
  v_and_or_b32 v0, v192, s67, v176
  v_and_or_b32 v1, v196, s67, v177
  v_and_or_b32 v2, v200, s67, v178
  v_and_or_b32 v3, v204, s67, v179
  v_and_or_b32 v4, v208, s67, v176
  v_and_or_b32 v5, v212, s67, v177
  v_and_or_b32 v6, v216, s67, v178
  v_and_or_b32 v7, v220, s67, v179
  v_and_or_b32 v8, v193, s67, v176
  v_and_or_b32 v9, v197, s67, v177
  v_and_or_b32 v10, v201, s67, v178
  v_and_or_b32 v11, v205, s67, v179
  v_and_or_b32 v12, v209, s67, v176
  v_and_or_b32 v13, v213, s67, v177
  v_and_or_b32 v14, v217, s67, v178
  v_and_or_b32 v15, v221, s67, v179
  v_and_or_b32 v16, v194, s67, v176
  v_and_or_b32 v17, v198, s67, v177
  v_and_or_b32 v18, v202, s67, v178
  v_and_or_b32 v19, v206, s67, v179
  v_and_or_b32 v20, v210, s67, v176
  v_and_or_b32 v21, v214, s67, v177
  v_and_or_b32 v22, v218, s67, v178
  v_and_or_b32 v23, v222, s67, v179
  v_and_or_b32 v24, v195, s67, v176
  v_and_or_b32 v25, v199, s67, v177
  v_and_or_b32 v26, v203, s67, v178
  v_and_or_b32 v27, v207, s67, v179
  v_and_or_b32 v28, v211, s67, v176
  v_and_or_b32 v29, v215, s67, v177
  v_and_or_b32 v30, v219, s67, v178
  v_and_or_b32 v31, v223, s67, v179
  s_mul_i32 s68, s73, 122880
  s_add_u32 s68, s68, s75
  v_lshlrev_b32 v164, 4, v243
  s_mov_b64 exec, 0xffff
  buffer_store_dwordx4 v[0:3], v164, s[40:43], s68 offen sc1
  buffer_store_dwordx4 v[4:7], v164, s[40:43], s68 offen offset:256 sc1
  s_add_u32 s68, s68, 30720
  buffer_store_dwordx4 v[8:11], v164, s[40:43], s68 offen sc1
  buffer_store_dwordx4 v[12:15], v164, s[40:43], s68 offen offset:256 sc1
  s_add_u32 s68, s68, 30720
  buffer_store_dwordx4 v[16:19], v164, s[40:43], s68 offen sc1
  buffer_store_dwordx4 v[20:23], v164, s[40:43], s68 offen offset:256 sc1
  s_add_u32 s68, s68, 30720
  buffer_store_dwordx4 v[24:27], v164, s[40:43], s68 offen sc1
  buffer_store_dwordx4 v[28:31], v164, s[40:43], s68 offen offset:256 sc1
  s_mov_b64 exec, -1
  s_branch L_s1_signal
L_s1_gate:
  s_cmp_lg_u32 s2, 198
  s_cbranch_scc1 L_s1_signal0
  s_mov_b32 s48, s22
  s_and_b32 s49, s23, 0xffff
  s_mov_b32 s50, 0x400
  s_mov_b32 s51, 0x00020000
  v_lshlrev_b32 v164, 4, v241
  buffer_load_dwordx4 v[16:19], v164, s[48:51], 0 offen
  buffer_load_dwordx4 v[0:3], v164, s[52:55], 0 offen offset:0
  buffer_load_dwordx4 v[4:7], v164, s[52:55], 0 offen offset:1024
  buffer_load_dwordx4 v[8:11], v164, s[52:55], 0 offen offset:2048
  buffer_load_dwordx4 v[12:15], v164, s[52:55], 0 offen offset:3072
  s_waitcnt vmcnt(0)
  v_mov_b32 v24, 0
  v_mov_b32 v25, 0
  v_mov_b32 v26, 0
  v_mov_b32 v27, 0
  v_lshlrev_b32 v20, 16, v16
  v_and_b32 v21, 0xffff0000, v16
  v_lshlrev_b32 v22, 16, v0
  v_and_b32 v23, 0xffff0000, v0
  v_mul_f32 v22, v20, v22
  v_mul_f32 v23, v21, v23
  v_cvt_pk_bf16_f32 v22, v22, v23
  v_and_b32 v23, 0xffff0000, v22
  v_lshlrev_b32 v22, 16, v22
  v_add_f32 v24, v24, v22
  v_add_f32 v24, v24, v23
  v_lshlrev_b32 v22, 16, v4
  v_and_b32 v23, 0xffff0000, v4
  v_mul_f32 v22, v20, v22
  v_mul_f32 v23, v21, v23
  v_cvt_pk_bf16_f32 v22, v22, v23
  v_and_b32 v23, 0xffff0000, v22
  v_lshlrev_b32 v22, 16, v22
  v_add_f32 v25, v25, v22
  v_add_f32 v25, v25, v23
  v_lshlrev_b32 v22, 16, v8
  v_and_b32 v23, 0xffff0000, v8
  v_mul_f32 v22, v20, v22
  v_mul_f32 v23, v21, v23
  v_cvt_pk_bf16_f32 v22, v22, v23
  v_and_b32 v23, 0xffff0000, v22
  v_lshlrev_b32 v22, 16, v22
  v_add_f32 v26, v26, v22
  v_add_f32 v26, v26, v23
  v_lshlrev_b32 v22, 16, v12
  v_and_b32 v23, 0xffff0000, v12
  v_mul_f32 v22, v20, v22
  v_mul_f32 v23, v21, v23
  v_cvt_pk_bf16_f32 v22, v22, v23
  v_and_b32 v23, 0xffff0000, v22
  v_lshlrev_b32 v22, 16, v22
  v_add_f32 v27, v27, v22
  v_add_f32 v27, v27, v23
  v_lshlrev_b32 v20, 16, v17
  v_and_b32 v21, 0xffff0000, v17
  v_lshlrev_b32 v22, 16, v1
  v_and_b32 v23, 0xffff0000, v1
  v_mul_f32 v22, v20, v22
  v_mul_f32 v23, v21, v23
  v_cvt_pk_bf16_f32 v22, v22, v23
  v_and_b32 v23, 0xffff0000, v22
  v_lshlrev_b32 v22, 16, v22
  v_add_f32 v24, v24, v22
  v_add_f32 v24, v24, v23
  v_lshlrev_b32 v22, 16, v5
  v_and_b32 v23, 0xffff0000, v5
  v_mul_f32 v22, v20, v22
  v_mul_f32 v23, v21, v23
  v_cvt_pk_bf16_f32 v22, v22, v23
  v_and_b32 v23, 0xffff0000, v22
  v_lshlrev_b32 v22, 16, v22
  v_add_f32 v25, v25, v22
  v_add_f32 v25, v25, v23
  v_lshlrev_b32 v22, 16, v9
  v_and_b32 v23, 0xffff0000, v9
  v_mul_f32 v22, v20, v22
  v_mul_f32 v23, v21, v23
  v_cvt_pk_bf16_f32 v22, v22, v23
  v_and_b32 v23, 0xffff0000, v22
  v_lshlrev_b32 v22, 16, v22
  v_add_f32 v26, v26, v22
  v_add_f32 v26, v26, v23
  v_lshlrev_b32 v22, 16, v13
  v_and_b32 v23, 0xffff0000, v13
  v_mul_f32 v22, v20, v22
  v_mul_f32 v23, v21, v23
  v_cvt_pk_bf16_f32 v22, v22, v23
  v_and_b32 v23, 0xffff0000, v22
  v_lshlrev_b32 v22, 16, v22
  v_add_f32 v27, v27, v22
  v_add_f32 v27, v27, v23
  v_lshlrev_b32 v20, 16, v18
  v_and_b32 v21, 0xffff0000, v18
  v_lshlrev_b32 v22, 16, v2
  v_and_b32 v23, 0xffff0000, v2
  v_mul_f32 v22, v20, v22
  v_mul_f32 v23, v21, v23
  v_cvt_pk_bf16_f32 v22, v22, v23
  v_and_b32 v23, 0xffff0000, v22
  v_lshlrev_b32 v22, 16, v22
  v_add_f32 v24, v24, v22
  v_add_f32 v24, v24, v23
  v_lshlrev_b32 v22, 16, v6
  v_and_b32 v23, 0xffff0000, v6
  v_mul_f32 v22, v20, v22
  v_mul_f32 v23, v21, v23
  v_cvt_pk_bf16_f32 v22, v22, v23
  v_and_b32 v23, 0xffff0000, v22
  v_lshlrev_b32 v22, 16, v22
  v_add_f32 v25, v25, v22
  v_add_f32 v25, v25, v23
  v_lshlrev_b32 v22, 16, v10
  v_and_b32 v23, 0xffff0000, v10
  v_mul_f32 v22, v20, v22
  v_mul_f32 v23, v21, v23
  v_cvt_pk_bf16_f32 v22, v22, v23
  v_and_b32 v23, 0xffff0000, v22
  v_lshlrev_b32 v22, 16, v22
  v_add_f32 v26, v26, v22
  v_add_f32 v26, v26, v23
  v_lshlrev_b32 v22, 16, v14
  v_and_b32 v23, 0xffff0000, v14
  v_mul_f32 v22, v20, v22
  v_mul_f32 v23, v21, v23
  v_cvt_pk_bf16_f32 v22, v22, v23
  v_and_b32 v23, 0xffff0000, v22
  v_lshlrev_b32 v22, 16, v22
  v_add_f32 v27, v27, v22
  v_add_f32 v27, v27, v23
  v_lshlrev_b32 v20, 16, v19
  v_and_b32 v21, 0xffff0000, v19
  v_lshlrev_b32 v22, 16, v3
  v_and_b32 v23, 0xffff0000, v3
  v_mul_f32 v22, v20, v22
  v_mul_f32 v23, v21, v23
  v_cvt_pk_bf16_f32 v22, v22, v23
  v_and_b32 v23, 0xffff0000, v22
  v_lshlrev_b32 v22, 16, v22
  v_add_f32 v24, v24, v22
  v_add_f32 v24, v24, v23
  v_lshlrev_b32 v22, 16, v7
  v_and_b32 v23, 0xffff0000, v7
  v_mul_f32 v22, v20, v22
  v_mul_f32 v23, v21, v23
  v_cvt_pk_bf16_f32 v22, v22, v23
  v_and_b32 v23, 0xffff0000, v22
  v_lshlrev_b32 v22, 16, v22
  v_add_f32 v25, v25, v22
  v_add_f32 v25, v25, v23
  v_lshlrev_b32 v22, 16, v11
  v_and_b32 v23, 0xffff0000, v11
  v_mul_f32 v22, v20, v22
  v_mul_f32 v23, v21, v23
  v_cvt_pk_bf16_f32 v22, v22, v23
  v_and_b32 v23, 0xffff0000, v22
  v_lshlrev_b32 v22, 16, v22
  v_add_f32 v26, v26, v22
  v_add_f32 v26, v26, v23
  v_lshlrev_b32 v22, 16, v15
  v_and_b32 v23, 0xffff0000, v15
  v_mul_f32 v22, v20, v22
  v_mul_f32 v23, v21, v23
  v_cvt_pk_bf16_f32 v22, v22, v23
  v_and_b32 v23, 0xffff0000, v22
  v_lshlrev_b32 v22, 16, v22
  v_add_f32 v27, v27, v22
  v_add_f32 v27, v27, v23
  s_nop 1
  v_add_f32_dpp v24, v24, v24 row_ror:8 row_mask:0xf bank_mask:0xf
  v_add_f32_dpp v25, v25, v25 row_ror:8 row_mask:0xf bank_mask:0xf
  v_add_f32_dpp v26, v26, v26 row_ror:8 row_mask:0xf bank_mask:0xf
  v_add_f32_dpp v27, v27, v27 row_ror:8 row_mask:0xf bank_mask:0xf
  s_nop 1
  v_add_f32_dpp v24, v24, v24 row_ror:4 row_mask:0xf bank_mask:0xf
  v_add_f32_dpp v25, v25, v25 row_ror:4 row_mask:0xf bank_mask:0xf
  v_add_f32_dpp v26, v26, v26 row_ror:4 row_mask:0xf bank_mask:0xf
  v_add_f32_dpp v27, v27, v27 row_ror:4 row_mask:0xf bank_mask:0xf
  s_nop 1
  v_add_f32_dpp v24, v24, v24 row_ror:2 row_mask:0xf bank_mask:0xf
  v_add_f32_dpp v25, v25, v25 row_ror:2 row_mask:0xf bank_mask:0xf
  v_add_f32_dpp v26, v26, v26 row_ror:2 row_mask:0xf bank_mask:0xf
  v_add_f32_dpp v27, v27, v27 row_ror:2 row_mask:0xf bank_mask:0xf
  s_nop 1
  v_add_f32_dpp v24, v24, v24 row_ror:1 row_mask:0xf bank_mask:0xf
  v_add_f32_dpp v25, v25, v25 row_ror:1 row_mask:0xf bank_mask:0xf
  v_add_f32_dpp v26, v26, v26 row_ror:1 row_mask:0xf bank_mask:0xf
  v_add_f32_dpp v27, v27, v27 row_ror:1 row_mask:0xf bank_mask:0xf
  v_mov_b32 v28, v24
  v_mov_b32 v29, v25
  v_mov_b32 v30, v26
  v_mov_b32 v31, v27
  s_nop 1
  v_permlane16_swap_b32 v24, v28
  v_permlane16_swap_b32 v25, v29
  v_permlane16_swap_b32 v26, v30
  v_permlane16_swap_b32 v27, v31
  v_add_f32 v24, v24, v28
  v_add_f32 v25, v25, v29
  v_add_f32 v26, v26, v30
  v_add_f32 v27, v27, v31
  v_mov_b32 v28, v24
  v_mov_b32 v29, v25
  v_mov_b32 v30, v26
  v_mov_b32 v31, v27
  s_nop 1
  v_permlane32_swap_b32 v24, v28
  v_permlane32_swap_b32 v25, v29
  v_permlane32_swap_b32 v26, v30
  v_permlane32_swap_b32 v27, v31
  v_add_f32 v24, v24, v28
  v_add_f32 v25, v25, v29
  v_add_f32 v26, v26, v30
  v_add_f32 v27, v27, v31
  v_cvt_pk_bf16_f32 v24, v24, v24
  v_cvt_pk_bf16_f32 v25, v25, v25
  v_cvt_pk_bf16_f32 v26, v26, v26
  v_cvt_pk_bf16_f32 v27, v27, v27
  v_lshlrev_b32 v24, 16, v24
  v_lshlrev_b32 v25, 16, v25
  v_lshlrev_b32 v26, 16, v26
  v_lshlrev_b32 v27, 16, v27
  v_mul_f32 v24, 0xbfb8aa3b, v24
  v_mul_f32 v25, 0xbfb8aa3b, v25
  v_mul_f32 v26, 0xbfb8aa3b, v26
  v_mul_f32 v27, 0xbfb8aa3b, v27
  v_exp_f32 v24, v24
  v_exp_f32 v25, v25
  v_exp_f32 v26, v26
  v_exp_f32 v27, v27
  s_nop 0
  v_add_f32 v24, 1.0, v24
  v_add_f32 v25, 1.0, v25
  v_add_f32 v26, 1.0, v26
  v_add_f32 v27, 1.0, v27
  v_rcp_f32 v24, v24
  v_rcp_f32 v25, v25
  v_rcp_f32 v26, v26
  v_rcp_f32 v27, v27
  s_nop 0
  v_cvt_pk_bf16_f32 v24, v24, v24
  v_cvt_pk_bf16_f32 v25, v25, v25
  v_cvt_pk_bf16_f32 v26, v26, v26
  v_cvt_pk_bf16_f32 v27, v27, v27
  v_lshlrev_b32 v24, 16, v24
  v_lshlrev_b32 v25, 16, v25
  v_lshlrev_b32 v26, 16, v26
  v_lshlrev_b32 v27, 16, v27
  s_mov_b32 s68, 0x80000
  v_mov_b32 v164, 0
  s_mov_b64 exec, 1
  buffer_store_dwordx4 v[24:27], v164, s[40:43], s68 offen sc1
  s_mov_b64 exec, -1
L_s1_signal0:
  s_waitcnt vmcnt(0)
  v_mov_b32 v164, 0
  s_mov_b64 exec, 1
L_pollNb:
  v_readfirstlane_b32 s78, v168
  v_readfirstlane_b32 s79, v169
  s_and_b32 s68, s78, 1
  s_lshr_b32 s69, s79, 31
  s_and_b32 s68, s68, s69
  s_cmp_eq_u32 s68, 1
  s_cbranch_scc1 L_pollNb_done
  s_add_u32 s83, s83, 1
  s_cmp_gt_u32 s83, 0x40000
  s_cbranch_scc1 L_pollNb_done
  buffer_load_dwordx2 v[168:169], v164, s[44:47], 0 offen sc1
  s_waitcnt vmcnt(0)
  s_branch L_pollNb
L_pollNb_done:
  s_mov_b64 exec, -1
  s_mul_i32 s68, s78, 0x9e3779b1
  s_mul_i32 s69, s78, 0x85ebca6b
  s_xor_b32 s69, s69, s79
  s_lshr_b32 s67, s68, 20
  v_mov_b32 v176, s67
  s_bfe_u32 s67, s68, 0xc0008
  v_mov_b32 v177, s67
  s_lshr_b32 s67, s69, 20
  v_mov_b32 v178, s67
  s_bfe_u32 s67, s69, 0xc0008
  v_mov_b32 v179, s67
  s_mov_b32 s67, 0xfffff000
L_s1_signal:
  v_and_b32 v164, 3, v241
  s_mov_b32 s68, 122880
  v_mul_lo_u32 v164, v164, s68
  v_lshrrev_b32 v165, 2, v241
  v_lshl_add_u32 v164, v165, 9, v164
  s_mul_i32 s68, s63, 30720
  s_lshl_b32 s69, s61, 11
  s_add_u32 s68, s68, s69
  s_mov_b32 s72, 0
  s_mov_b64 exec, 0xffff
L_poll0:
  buffer_load_dwordx4 v[180:183], v164, s[40:43], s68 offen offset:496 sc1
  s_waitcnt vmcnt(0)
  s_cmp_lg_u32 s72, 0
  s_cbranch_scc1 L_noflagst
  s_mov_b32 s72, 1
  s_lshl_b32 s69, s2, 7
  s_add_u32 s69, s69, 0x300000
  v_mov_b32 v165, 0
  s_mov_b64 exec, 1
  buffer_store_dwordx2 v[168:169], v165, s[40:43], s69 offen sc1
  s_mov_b64 exec, 0xffff
L_noflagst:
  v_xor_b32 v184, v180, v176
  v_xor_b32 v185, v181, v177
  v_or_b32 v184, v184, v185
  v_xor_b32 v185, v182, v178
  v_or_b32 v184, v184, v185
  v_xor_b32 v185, v183, v179
  v_or_b32 v184, v184, v185
  v_and_b32 v184, 0xfff, v184
  v_cmp_ne_u32 vcc, 0, v184
  s_nop 1
  s_cmp_eq_u64 vcc, 0
  s_cbranch_scc1 L_poll0_done
  s_add_u32 s83, s83, 1
  s_cmp_gt_u32 s83, 0x40000
  s_cbranch_scc1 L_poll0_done
  s_branch L_poll0
L_poll0_done:
  s_mov_b64 exec, -1
  v_lshlrev_b32 v164, 9, v242
  v_lshl_add_u32 v164, v243, 4, v164
L_gath:
  s_mov_b32 s69, s68
  buffer_load_dwordx4 v[0:3], v164, s[40:43], s69 offen sc1
  buffer_load_dwordx4 v[4:7], v164, s[40:43], s69 offen offset:256 sc1
  s_add_u32 s69, s69, 122880
  buffer_load_dwordx4 v[8:11], v164, s[40:43], s69 offen sc1
  buffer_load_dwordx4 v[12:15], v164, s[40:43], s69 offen offset:256 sc1
  s_add_u32 s69, s69, 122880
  buffer_load_dwordx4 v[16:19], v164, s[40:43], s69 offen sc1
  buffer_load_dwordx4 v[20:23], v164, s[40:43], s69 offen offset:256 sc1
  s_add_u32 s69, s69, 122880
  buffer_load_dwordx4 v[24:27], v164, s[40:43], s69 offen sc1
  buffer_load_dwordx4 v[28:31], v164, s[40:43], s69 offen offset:256 sc1
  s_waitcnt vmcnt(0)
  v_xor_b32 v184, v0, v176
  v_xor_b32 v185, v1, v177
  v_or_b32 v184, v184, v185
  v_xor_b32 v185, v2, v178
  v_or_b32 v184, v184, v185
  v_xor_b32 v185, v3, v179
  v_or_b32 v184, v184, v185
  v_xor_b32 v185, v4, v176
  v_or_b32 v184, v184, v185
  v_xor_b32 v185, v5, v177
  v_or_b32 v184, v184, v185
  v_xor_b32 v185, v6, v178
  v_or_b32 v184, v184, v185
  v_xor_b32 v185, v7, v179
  v_or_b32 v184, v184, v185
  v_xor_b32 v185, v8, v176
  v_or_b32 v184, v184, v185
  v_xor_b32 v185, v9, v177
  v_or_b32 v184, v184, v185
  v_xor_b32 v185, v10, v178
  v_or_b32 v184, v184, v185
  v_xor_b32 v185, v11, v179
  v_or_b32 v184, v184, v185
  v_xor_b32 v185, v12, v176
  v_or_b32 v184, v184, v185
  v_xor_b32 v185, v13, v177
  v_or_b32 v184, v184, v185
  v_xor_b32 v185, v14, v178
  v_or_b32 v184, v184, v185
  v_xor_b32 v185, v15, v179
  v_or_b32 v184, v184, v185
  v_xor_b32 v185, v16, v176
  v_or_b32 v184, v184, v185
  v_xor_b32 v185, v17, v177
  v_or_b32 v184, v184, v185
  v_xor_b32 v185, v18, v178
  v_or_b32 v184, v184, v185
  v_xor_b32 v185, v19, v179
  v_or_b32 v184, v184, v185
  v_xor_b32 v185, v20, v176
  v_or_b32 v184, v184, v185
  v_xor_b32 v185, v21, v177
  v_or_b32 v184, v184, v185
  v_xor_b32 v185, v22, v178
  v_or_b32 v184, v184, v185
  v_xor_b32 v185, v23, v179
  v_or_b32 v184, v184, v185
  v_xor_b32 v185, v24, v176
  v_or_b32 v184, v184, v185
  v_xor_b32 v185, v25, v177
  v_or_b32 v184, v184, v185
  v_xor_b32 v185, v26, v178
  v_or_b32 v184, v184, v185
  v_xor_b32 v185, v27, v179
  v_or_b32 v184, v184, v185
  v_xor_b32 v185, v28, v176
  v_or_b32 v184, v184, v185
  v_xor_b32 v185, v29, v177
  v_or_b32 v184, v184, v185
  v_xor_b32 v185, v30, v178
  v_or_b32 v184, v184, v185
  v_xor_b32 v185, v31, v179
  v_or_b32 v184, v184, v185
  v_and_b32 v184, 0xfff, v184
  v_cmp_ne_u32 vcc, 0, v184
  s_nop 1
  s_cmp_eq_u64 vcc, 0
  s_cbranch_scc1 L_gath_done
  s_add_u32 s83, s83, 1
  s_cmp_gt_u32 s83, 0x40000
  s_cbranch_scc1 L_gath_done
  s_branch L_gath
L_gath_done:
  v_add_f32 v0, v0, v8
  v_add_f32 v16, v16, v24
  v_add_f32 v1, v1, v9
  v_add_f32 v17, v17, v25
  v_add_f32 v2, v2, v10
  v_add_f32 v18, v18, v26
  v_add_f32 v3, v3, v11
  v_add_f32 v19, v19, v27
  v_add_f32 v4, v4, v12
  v_add_f32 v20, v20, v28
  v_add_f32 v5, v5, v13
  v_add_f32 v21, v21, v29
  v_add_f32 v6, v6, v14
  v_add_f32 v22, v22, v30
  v_add_f32 v7, v7, v15
  v_add_f32 v23, v23, v31
  v_add_f32 v0, v0, v16
  v_add_f32 v1, v1, v17
  v_add_f32 v2, v2, v18
  v_add_f32 v3, v3, v19
  v_add_f32 v4, v4, v20
  v_add_f32 v5, v5, v21
  v_add_f32 v6, v6, v22
  v_add_f32 v7, v7, v23
  v_cvt_pk_bf16_f32 v32, v0, v1
  v_cvt_pk_bf16_f32 v33, v2, v3
  v_cvt_pk_bf16_f32 v34, v4, v5
  v_cvt_pk_bf16_f32 v35, v6, v7
  v_lshlrev_b32 v164, 4, v241
  ds_write_b128 v164, v[32:35] offset:0
  v_mov_b32 v164, 17672
  v_mov_b32 v166, s78
  v_mov_b32 v167, s79
  ds_write_b64 v164, v[166:167]
  s_waitcnt lgkmcnt(0)
  v_mov_b32 v164, 17664
  v_mov_b32 v165, 2
  ds_write_b32 v164, v165
  s_setprio 0
  v_mov_b32 v0, 0
  v_mov_b32 v1, 0
  v_mov_b32 v2, 0
  v_mov_b32 v3, 0
  v_lshlrev_b32 v164, 5, v241
  ds_write_b128 v164, v[0:3] offset:1024
  ds_write_b128 v164, v[0:3] offset:1040
  v_mov_b32 v0, 0xf149f2ca
  v_and_b32 v164, 3, v241
  v_lshlrev_b32 v164, 3, v164
  ds_write_b64 v164, v[0:1] offset:17408
  s_waitcnt lgkmcnt(0)
  v_lshlrev_b32 v168, 2, v242
  v_xor_b32 v168, v168, v243
  v_lshlrev_b32 v168, 4, v168
  v_lshl_add_u32 v168, v242, 8, v168
  v_lshlrev_b32 v169, 2, v242
  v_add_u32 v169, 1, v169
  v_xor_b32 v169, v169, v243
  v_lshlrev_b32 v169, 4, v169
  v_lshl_add_u32 v169, v242, 8, v169
  v_lshlrev_b32 v170, 2, v242
  v_add_u32 v170, 2, v170
  v_xor_b32 v170, v170, v243
  v_lshlrev_b32 v170, 4, v170
  v_lshl_add_u32 v170, v242, 8, v170
  v_lshlrev_b32 v171, 2, v242
  v_add_u32 v171, 3, v171
  v_xor_b32 v171, v171, v243
  v_lshlrev_b32 v171, 4, v171
  v_lshl_add_u32 v171, v242, 8, v171
  v_and_b32 v252, 3, v243
  v_lshlrev_b32 v252, 2, v252
  v_lshrrev_b32 v253, 2, v243
  v_add_u32 v252, v252, v253
  v_lshlrev_b32 v252, 8, v252
  v_add_u32 v252, s77, v252
  v_add_u32 v172, 0, v242
  v_xor_b32 v172, v172, v243
  v_lshl_add_u32 v172, v172, 4, v252
  v_add_u32 v173, 4, v242
  v_xor_b32 v173, v173, v243
  v_lshl_add_u32 v173, v173, 4, v252
  v_add_u32 v174, 8, v242
  v_xor_b32 v174, v174, v243
  v_lshl_add_u32 v174, v174, 4, v252
  v_add_u32 v175, 12, v242
  v_xor_b32 v175, v175, v243
  v_lshl_add_u32 v175, v175, 4, v252
  s_branch L_pool_nogate
.section .rodata,"a"
.p2align 6
.amdhsa_kernel gated_mix__gqa_block_cached__glu_gated_glu__decode_kernel
  .amdhsa_next_free_vgpr 256
  .amdhsa_next_free_sgpr 102
  .amdhsa_accum_offset 256
  .amdhsa_group_segment_fixed_size 0
  .amdhsa_kernarg_size 104
  .amdhsa_user_sgpr_count 2
  .amdhsa_user_sgpr_kernarg_segment_ptr 1
  .amdhsa_system_sgpr_workgroup_id_x 1
.end_amdhsa_kernel
```
